```python
import torch

def _softmax(x, axis=-1):
    return torch.softmax(x, dim=axis)

def _gelu(x):
    return torch.nn.functional.gelu(x, approximate='tanh')

def _silu(x):
    return torch.nn.functional.silu(x)

def _sigmoid(x):
    return torch.sigmoid(x)

def _layernorm(x, axis=-1, eps=1e-05):
    m = x.mean(dim=axis, keepdim=True)
    v = x.var(dim=axis, keepdim=True, unbiased=False)
    return (x - m) / torch.sqrt(v + eps)

def _scatter_add(tgt, idx, src, axis=0):
    return tgt.clone().index_add_(axis, idx, src)

def _segment_sum(src, seg, n):
    out = torch.zeros((n,) + src.shape[1:], dtype=src.dtype)
    return out.index_add_(0, seg, src)

def _pad(x, pw):
    flat = tuple((v for pair in reversed(pw) for v in pair))
    return torch.nn.functional.pad(x, flat)
kernel_name = 'standalone__dit_block__diffusion'

def setup_inputs():

    _w = lambda a: (lambda t: t.to(torch.bfloat16) if t.is_floating_point() else t)(torch.as_tensor(a))
    B, N, D = (2, 1024, 768)
    F = 4 * D
    return {'x': _w((lambda *s: torch.randn(*s, dtype=torch.bfloat16) * 0.05)(B, N, D)), 'c': _w((lambda *s: torch.randn(*s, dtype=torch.bfloat16) * 0.2)(B, D)), 'wqkv': _w((lambda *s: torch.randn(*s, dtype=torch.bfloat16) * 0.05)(D, 3 * D)), 'wo': _w((lambda *s: torch.randn(*s, dtype=torch.bfloat16) * 0.05)(D, D)), 'w_mod': _w((lambda *s: torch.randn(*s, dtype=torch.bfloat16) * 0.2)(D, 6 * D)), 'w_fc1': _w((lambda *s: torch.randn(*s, dtype=torch.bfloat16) * 0.05)(D, F)), 'w_fc2': _w((lambda *s: torch.randn(*s, dtype=torch.bfloat16) * 0.05)(F, D))}

def reference(x, c, wqkv, wo, w_mod, w_fc1, w_fc2):
    B, N, D = x.shape
    H = 2
    Dh = D // H
    mod = (_silu(c) @ w_mod).reshape(B, 6, 1, D)
    shift_a, scale_a, gate_a, shift_m, scale_m, gate_m = [mod[:, i] for i in range(6)]
    h = _layernorm(x, axis=-1) * (1 + scale_a) + shift_a
    qkv = (h @ wqkv).reshape(B, N, 3, H, Dh)
    q, k, v = (qkv[:, :, 0].clone(), qkv[:, :, 1].clone(), qkv[:, :, 2].clone())
    attn = _softmax(torch.einsum('bqhd,bkhd->bhqk', q, k) * Dh ** (-0.5), axis=-1)
    a = torch.einsum('bhqk,bkhd->bqhd', attn, v).reshape(B, N, D) @ wo
    x = x + gate_a * a
    h2 = _layernorm(x, axis=-1) * (1 + scale_m) + shift_m
    m = _gelu(h2 @ w_fc1) @ w_fc2
    return x + gate_m * m
```

```asm
; @launch kernel=dit_mod_kernel grid=(36,1,1) block=(512,1,1) lds=8192
; @launch kernel=dit_ln1_kernel grid=(512,1,1) block=(256,1,1) lds=0
; @launch kernel=dit_qkv_kernel grid=(192,1,1) block=(512,1,1) lds=163840
; @launch kernel=dit_s_kernel grid=(256,1,1) block=(512,1,1) lds=131072
; @launch kernel=dit_softmax_kernel grid=(1024,1,1) block=(256,1,1) lds=0
; @launch kernel=dit_pv_kernel grid=(256,1,1) block=(512,1,1) lds=143360
; @launch kernel=dit_wo_kernel grid=(256,1,1) block=(512,1,1) lds=143360
; @launch kernel=dit_ln2_kernel grid=(512,1,1) block=(256,1,1) lds=0
; @launch kernel=dit_fc1_kernel grid=(256,1,1) block=(512,1,1) lds=163840
; @launch kernel=dit_fc2_kernel grid=(256,1,1) block=(512,1,1) lds=143360
.amdgcn_target "amdgcn-amd-amdhsa--gfx950"
.text
.globl dit_mod_kernel
.p2align 8
.type dit_mod_kernel,@function
dit_mod_kernel:
    s_cmp_ge_u32 s2, 36
    s_cbranch_scc1 L_dit_mod_kernel_1
    s_load_dwordx2 s[4:5], s[0:1], 8
    s_load_dwordx2 s[6:7], s[0:1], 32
    s_load_dwordx2 s[8:9], s[0:1], 72
    v_lshrrev_b32 v1, 6, v0
    v_and_b32 v2, 63, v0
    s_nop 0
    v_readfirstlane_b32 s3, v1
    s_waitcnt lgkmcnt(0)
    s_mov_b32 s12, s4
    s_mov_b32 s13, s5
    s_mov_b32 s14, 3072
    s_mov_b32 s15, 0x00020000
    s_mov_b32 s16, s6
    s_mov_b32 s17, s7
    s_mov_b32 s18, 7077888
    s_mov_b32 s19, 0x00020000
    s_mov_b32 s20, s8
    s_mov_b32 s21, s9
    s_mov_b32 s22, 36864
    s_mov_b32 s23, 0x00020000
    s_mul_i32 s24, s3, 96
    v_add_u32 v3, s24, v2
    v_lshlrev_b32 v3, 1, v3
    buffer_load_ushort v4, v3, s[12:15], 0 offen
    buffer_load_ushort v5, v3, s[12:15], 0 offen offset:128
    buffer_load_ushort v6, v3, s[12:15], 0 offen offset:1536
    buffer_load_ushort v7, v3, s[12:15], 0 offen offset:1664
    s_waitcnt vmcnt(0)
    v_lshlrev_b32 v4, 16, v4
    v_lshlrev_b32 v5, 16, v5
    v_lshlrev_b32 v6, 16, v6
    v_lshlrev_b32 v7, 16, v7
    s_mov_b32 s25, 0xbfb8aa3b
    v_mul_f32 v8, s25, v4
    v_mul_f32 v9, s25, v5
    v_mul_f32 v10, s25, v6
    v_mul_f32 v11, s25, v7
    v_exp_f32 v8, v8
    v_exp_f32 v9, v9
    v_exp_f32 v10, v10
    v_exp_f32 v11, v11
    s_nop 0
    v_add_f32 v8, 1.0, v8
    v_add_f32 v9, 1.0, v9
    v_add_f32 v10, 1.0, v10
    v_add_f32 v11, 1.0, v11
    v_rcp_f32 v8, v8
    v_rcp_f32 v9, v9
    v_rcp_f32 v10, v10
    v_rcp_f32 v11, v11
    s_nop 0
    v_mul_f32 v4, v4, v8
    v_mul_f32 v5, v5, v9
    v_mul_f32 v6, v6, v10
    v_mul_f32 v7, v7, v11
    v_cvt_pk_bf16_f32 v12, v4, v5
    v_lshlrev_b32 v4, 16, v12
    v_and_b32 v5, 0xffff0000, v12
    v_cvt_pk_bf16_f32 v12, v6, v7
    v_lshlrev_b32 v6, 16, v12
    v_and_b32 v7, 0xffff0000, v12
    s_lshl_b32 s26, s2, 8
    s_mul_i32 s27, s24, 9216
    s_add_u32 s26, s26, s27
    v_lshlrev_b32 v13, 2, v2
    v_add_u32 v13, s26, v13
    v_mov_b32 v14, 0
    v_mov_b32 v15, 0
    v_mov_b32 v16, 0
    v_mov_b32 v17, 0
    s_mov_b32 s28, 0
    buffer_load_dword v32, v13, s[16:19], s28 offen
    s_add_u32 s28, s28, 9216
    buffer_load_dword v33, v13, s[16:19], s28 offen
    s_add_u32 s28, s28, 9216
    buffer_load_dword v34, v13, s[16:19], s28 offen
    s_add_u32 s28, s28, 9216
    buffer_load_dword v35, v13, s[16:19], s28 offen
    s_add_u32 s28, s28, 9216
    buffer_load_dword v36, v13, s[16:19], s28 offen
    s_add_u32 s28, s28, 9216
    buffer_load_dword v37, v13, s[16:19], s28 offen
    s_add_u32 s28, s28, 9216
    buffer_load_dword v38, v13, s[16:19], s28 offen
    s_add_u32 s28, s28, 9216
    buffer_load_dword v39, v13, s[16:19], s28 offen
    s_add_u32 s28, s28, 9216
    buffer_load_dword v40, v13, s[16:19], s28 offen
    s_add_u32 s28, s28, 9216
    buffer_load_dword v41, v13, s[16:19], s28 offen
    s_add_u32 s28, s28, 9216
    buffer_load_dword v42, v13, s[16:19], s28 offen
    s_add_u32 s28, s28, 9216
    buffer_load_dword v43, v13, s[16:19], s28 offen
    s_add_u32 s28, s28, 9216
    buffer_load_dword v44, v13, s[16:19], s28 offen
    s_add_u32 s28, s28, 9216
    buffer_load_dword v45, v13, s[16:19], s28 offen
    s_add_u32 s28, s28, 9216
    buffer_load_dword v46, v13, s[16:19], s28 offen
    s_add_u32 s28, s28, 9216
    buffer_load_dword v47, v13, s[16:19], s28 offen
    s_add_u32 s28, s28, 9216
    v_readlane_b32 s30, v4, 0
    v_readlane_b32 s31, v6, 0
    s_waitcnt vmcnt(15)
    v_lshlrev_b32 v18, 16, v32
    v_and_b32 v19, 0xffff0000, v32
    v_fma_f32 v14, v18, s30, v14
    v_fma_f32 v15, v19, s30, v15
    v_fma_f32 v16, v18, s31, v16
    v_fma_f32 v17, v19, s31, v17
    v_readlane_b32 s30, v4, 1
    v_readlane_b32 s31, v6, 1
    s_waitcnt vmcnt(14)
    v_lshlrev_b32 v18, 16, v33
    v_and_b32 v19, 0xffff0000, v33
    v_fma_f32 v14, v18, s30, v14
    v_fma_f32 v15, v19, s30, v15
    v_fma_f32 v16, v18, s31, v16
    v_fma_f32 v17, v19, s31, v17
    v_readlane_b32 s30, v4, 2
    v_readlane_b32 s31, v6, 2
    s_waitcnt vmcnt(13)
    v_lshlrev_b32 v18, 16, v34
    v_and_b32 v19, 0xffff0000, v34
    v_fma_f32 v14, v18, s30, v14
    v_fma_f32 v15, v19, s30, v15
    v_fma_f32 v16, v18, s31, v16
    v_fma_f32 v17, v19, s31, v17
    v_readlane_b32 s30, v4, 3
    v_readlane_b32 s31, v6, 3
    s_waitcnt vmcnt(12)
    v_lshlrev_b32 v18, 16, v35
    v_and_b32 v19, 0xffff0000, v35
    v_fma_f32 v14, v18, s30, v14
    v_fma_f32 v15, v19, s30, v15
    v_fma_f32 v16, v18, s31, v16
    v_fma_f32 v17, v19, s31, v17
    v_readlane_b32 s30, v4, 4
    v_readlane_b32 s31, v6, 4
    s_waitcnt vmcnt(11)
    v_lshlrev_b32 v18, 16, v36
    v_and_b32 v19, 0xffff0000, v36
    v_fma_f32 v14, v18, s30, v14
    v_fma_f32 v15, v19, s30, v15
    v_fma_f32 v16, v18, s31, v16
    v_fma_f32 v17, v19, s31, v17
    v_readlane_b32 s30, v4, 5
    v_readlane_b32 s31, v6, 5
    s_waitcnt vmcnt(10)
    v_lshlrev_b32 v18, 16, v37
    v_and_b32 v19, 0xffff0000, v37
    v_fma_f32 v14, v18, s30, v14
    v_fma_f32 v15, v19, s30, v15
    v_fma_f32 v16, v18, s31, v16
    v_fma_f32 v17, v19, s31, v17
    v_readlane_b32 s30, v4, 6
    v_readlane_b32 s31, v6, 6
    s_waitcnt vmcnt(9)
    v_lshlrev_b32 v18, 16, v38
    v_and_b32 v19, 0xffff0000, v38
    v_fma_f32 v14, v18, s30, v14
    v_fma_f32 v15, v19, s30, v15
    v_fma_f32 v16, v18, s31, v16
    v_fma_f32 v17, v19, s31, v17
    v_readlane_b32 s30, v4, 7
    v_readlane_b32 s31, v6, 7
    s_waitcnt vmcnt(8)
    v_lshlrev_b32 v18, 16, v39
    v_and_b32 v19, 0xffff0000, v39
    v_fma_f32 v14, v18, s30, v14
    v_fma_f32 v15, v19, s30, v15
    v_fma_f32 v16, v18, s31, v16
    v_fma_f32 v17, v19, s31, v17
    v_readlane_b32 s30, v4, 8
    v_readlane_b32 s31, v6, 8
    s_waitcnt vmcnt(7)
    v_lshlrev_b32 v18, 16, v40
    v_and_b32 v19, 0xffff0000, v40
    v_fma_f32 v14, v18, s30, v14
    v_fma_f32 v15, v19, s30, v15
    v_fma_f32 v16, v18, s31, v16
    v_fma_f32 v17, v19, s31, v17
    v_readlane_b32 s30, v4, 9
    v_readlane_b32 s31, v6, 9
    s_waitcnt vmcnt(6)
    v_lshlrev_b32 v18, 16, v41
    v_and_b32 v19, 0xffff0000, v41
    v_fma_f32 v14, v18, s30, v14
    v_fma_f32 v15, v19, s30, v15
    v_fma_f32 v16, v18, s31, v16
    v_fma_f32 v17, v19, s31, v17
    v_readlane_b32 s30, v4, 10
    v_readlane_b32 s31, v6, 10
    s_waitcnt vmcnt(5)
    v_lshlrev_b32 v18, 16, v42
    v_and_b32 v19, 0xffff0000, v42
    v_fma_f32 v14, v18, s30, v14
    v_fma_f32 v15, v19, s30, v15
    v_fma_f32 v16, v18, s31, v16
    v_fma_f32 v17, v19, s31, v17
    v_readlane_b32 s30, v4, 11
    v_readlane_b32 s31, v6, 11
    s_waitcnt vmcnt(4)
    v_lshlrev_b32 v18, 16, v43
    v_and_b32 v19, 0xffff0000, v43
    v_fma_f32 v14, v18, s30, v14
    v_fma_f32 v15, v19, s30, v15
    v_fma_f32 v16, v18, s31, v16
    v_fma_f32 v17, v19, s31, v17
    v_readlane_b32 s30, v4, 12
    v_readlane_b32 s31, v6, 12
    s_waitcnt vmcnt(3)
    v_lshlrev_b32 v18, 16, v44
    v_and_b32 v19, 0xffff0000, v44
    v_fma_f32 v14, v18, s30, v14
    v_fma_f32 v15, v19, s30, v15
    v_fma_f32 v16, v18, s31, v16
    v_fma_f32 v17, v19, s31, v17
    v_readlane_b32 s30, v4, 13
    v_readlane_b32 s31, v6, 13
    s_waitcnt vmcnt(2)
    v_lshlrev_b32 v18, 16, v45
    v_and_b32 v19, 0xffff0000, v45
    v_fma_f32 v14, v18, s30, v14
    v_fma_f32 v15, v19, s30, v15
    v_fma_f32 v16, v18, s31, v16
    v_fma_f32 v17, v19, s31, v17
    v_readlane_b32 s30, v4, 14
    v_readlane_b32 s31, v6, 14
    s_waitcnt vmcnt(1)
    v_lshlrev_b32 v18, 16, v46
    v_and_b32 v19, 0xffff0000, v46
    v_fma_f32 v14, v18, s30, v14
    v_fma_f32 v15, v19, s30, v15
    v_fma_f32 v16, v18, s31, v16
    v_fma_f32 v17, v19, s31, v17
    v_readlane_b32 s30, v4, 15
    v_readlane_b32 s31, v6, 15
    s_waitcnt vmcnt(0)
    v_lshlrev_b32 v18, 16, v47
    v_and_b32 v19, 0xffff0000, v47
    v_fma_f32 v14, v18, s30, v14
    v_fma_f32 v15, v19, s30, v15
    v_fma_f32 v16, v18, s31, v16
    v_fma_f32 v17, v19, s31, v17
    buffer_load_dword v32, v13, s[16:19], s28 offen
    s_add_u32 s28, s28, 9216
    buffer_load_dword v33, v13, s[16:19], s28 offen
    s_add_u32 s28, s28, 9216
    buffer_load_dword v34, v13, s[16:19], s28 offen
    s_add_u32 s28, s28, 9216
    buffer_load_dword v35, v13, s[16:19], s28 offen
    s_add_u32 s28, s28, 9216
    buffer_load_dword v36, v13, s[16:19], s28 offen
    s_add_u32 s28, s28, 9216
    buffer_load_dword v37, v13, s[16:19], s28 offen
    s_add_u32 s28, s28, 9216
    buffer_load_dword v38, v13, s[16:19], s28 offen
    s_add_u32 s28, s28, 9216
    buffer_load_dword v39, v13, s[16:19], s28 offen
    s_add_u32 s28, s28, 9216
    buffer_load_dword v40, v13, s[16:19], s28 offen
    s_add_u32 s28, s28, 9216
    buffer_load_dword v41, v13, s[16:19], s28 offen
    s_add_u32 s28, s28, 9216
    buffer_load_dword v42, v13, s[16:19], s28 offen
    s_add_u32 s28, s28, 9216
    buffer_load_dword v43, v13, s[16:19], s28 offen
    s_add_u32 s28, s28, 9216
    buffer_load_dword v44, v13, s[16:19], s28 offen
    s_add_u32 s28, s28, 9216
    buffer_load_dword v45, v13, s[16:19], s28 offen
    s_add_u32 s28, s28, 9216
    buffer_load_dword v46, v13, s[16:19], s28 offen
    s_add_u32 s28, s28, 9216
    buffer_load_dword v47, v13, s[16:19], s28 offen
    s_add_u32 s28, s28, 9216
    v_readlane_b32 s30, v4, 16
    v_readlane_b32 s31, v6, 16
    s_waitcnt vmcnt(15)
    v_lshlrev_b32 v18, 16, v32
    v_and_b32 v19, 0xffff0000, v32
    v_fma_f32 v14, v18, s30, v14
    v_fma_f32 v15, v19, s30, v15
    v_fma_f32 v16, v18, s31, v16
    v_fma_f32 v17, v19, s31, v17
    v_readlane_b32 s30, v4, 17
    v_readlane_b32 s31, v6, 17
    s_waitcnt vmcnt(14)
    v_lshlrev_b32 v18, 16, v33
    v_and_b32 v19, 0xffff0000, v33
    v_fma_f32 v14, v18, s30, v14
    v_fma_f32 v15, v19, s30, v15
    v_fma_f32 v16, v18, s31, v16
    v_fma_f32 v17, v19, s31, v17
    v_readlane_b32 s30, v4, 18
    v_readlane_b32 s31, v6, 18
    s_waitcnt vmcnt(13)
    v_lshlrev_b32 v18, 16, v34
    v_and_b32 v19, 0xffff0000, v34
    v_fma_f32 v14, v18, s30, v14
    v_fma_f32 v15, v19, s30, v15
    v_fma_f32 v16, v18, s31, v16
    v_fma_f32 v17, v19, s31, v17
    v_readlane_b32 s30, v4, 19
    v_readlane_b32 s31, v6, 19
    s_waitcnt vmcnt(12)
    v_lshlrev_b32 v18, 16, v35
    v_and_b32 v19, 0xffff0000, v35
    v_fma_f32 v14, v18, s30, v14
    v_fma_f32 v15, v19, s30, v15
    v_fma_f32 v16, v18, s31, v16
    v_fma_f32 v17, v19, s31, v17
    v_readlane_b32 s30, v4, 20
    v_readlane_b32 s31, v6, 20
    s_waitcnt vmcnt(11)
    v_lshlrev_b32 v18, 16, v36
    v_and_b32 v19, 0xffff0000, v36
    v_fma_f32 v14, v18, s30, v14
    v_fma_f32 v15, v19, s30, v15
    v_fma_f32 v16, v18, s31, v16
    v_fma_f32 v17, v19, s31, v17
    v_readlane_b32 s30, v4, 21
    v_readlane_b32 s31, v6, 21
    s_waitcnt vmcnt(10)
    v_lshlrev_b32 v18, 16, v37
    v_and_b32 v19, 0xffff0000, v37
    v_fma_f32 v14, v18, s30, v14
    v_fma_f32 v15, v19, s30, v15
    v_fma_f32 v16, v18, s31, v16
    v_fma_f32 v17, v19, s31, v17
    v_readlane_b32 s30, v4, 22
    v_readlane_b32 s31, v6, 22
    s_waitcnt vmcnt(9)
    v_lshlrev_b32 v18, 16, v38
    v_and_b32 v19, 0xffff0000, v38
    v_fma_f32 v14, v18, s30, v14
    v_fma_f32 v15, v19, s30, v15
    v_fma_f32 v16, v18, s31, v16
    v_fma_f32 v17, v19, s31, v17
    v_readlane_b32 s30, v4, 23
    v_readlane_b32 s31, v6, 23
    s_waitcnt vmcnt(8)
    v_lshlrev_b32 v18, 16, v39
    v_and_b32 v19, 0xffff0000, v39
    v_fma_f32 v14, v18, s30, v14
    v_fma_f32 v15, v19, s30, v15
    v_fma_f32 v16, v18, s31, v16
    v_fma_f32 v17, v19, s31, v17
    v_readlane_b32 s30, v4, 24
    v_readlane_b32 s31, v6, 24
    s_waitcnt vmcnt(7)
    v_lshlrev_b32 v18, 16, v40
    v_and_b32 v19, 0xffff0000, v40
    v_fma_f32 v14, v18, s30, v14
    v_fma_f32 v15, v19, s30, v15
    v_fma_f32 v16, v18, s31, v16
    v_fma_f32 v17, v19, s31, v17
    v_readlane_b32 s30, v4, 25
    v_readlane_b32 s31, v6, 25
    s_waitcnt vmcnt(6)
    v_lshlrev_b32 v18, 16, v41
    v_and_b32 v19, 0xffff0000, v41
    v_fma_f32 v14, v18, s30, v14
    v_fma_f32 v15, v19, s30, v15
    v_fma_f32 v16, v18, s31, v16
    v_fma_f32 v17, v19, s31, v17
    v_readlane_b32 s30, v4, 26
    v_readlane_b32 s31, v6, 26
    s_waitcnt vmcnt(5)
    v_lshlrev_b32 v18, 16, v42
    v_and_b32 v19, 0xffff0000, v42
    v_fma_f32 v14, v18, s30, v14
    v_fma_f32 v15, v19, s30, v15
    v_fma_f32 v16, v18, s31, v16
    v_fma_f32 v17, v19, s31, v17
    v_readlane_b32 s30, v4, 27
    v_readlane_b32 s31, v6, 27
    s_waitcnt vmcnt(4)
    v_lshlrev_b32 v18, 16, v43
    v_and_b32 v19, 0xffff0000, v43
    v_fma_f32 v14, v18, s30, v14
    v_fma_f32 v15, v19, s30, v15
    v_fma_f32 v16, v18, s31, v16
    v_fma_f32 v17, v19, s31, v17
    v_readlane_b32 s30, v4, 28
    v_readlane_b32 s31, v6, 28
    s_waitcnt vmcnt(3)
    v_lshlrev_b32 v18, 16, v44
    v_and_b32 v19, 0xffff0000, v44
    v_fma_f32 v14, v18, s30, v14
    v_fma_f32 v15, v19, s30, v15
    v_fma_f32 v16, v18, s31, v16
    v_fma_f32 v17, v19, s31, v17
    v_readlane_b32 s30, v4, 29
    v_readlane_b32 s31, v6, 29
    s_waitcnt vmcnt(2)
    v_lshlrev_b32 v18, 16, v45
    v_and_b32 v19, 0xffff0000, v45
    v_fma_f32 v14, v18, s30, v14
    v_fma_f32 v15, v19, s30, v15
    v_fma_f32 v16, v18, s31, v16
    v_fma_f32 v17, v19, s31, v17
    v_readlane_b32 s30, v4, 30
    v_readlane_b32 s31, v6, 30
    s_waitcnt vmcnt(1)
    v_lshlrev_b32 v18, 16, v46
    v_and_b32 v19, 0xffff0000, v46
    v_fma_f32 v14, v18, s30, v14
    v_fma_f32 v15, v19, s30, v15
    v_fma_f32 v16, v18, s31, v16
    v_fma_f32 v17, v19, s31, v17
    v_readlane_b32 s30, v4, 31
    v_readlane_b32 s31, v6, 31
    s_waitcnt vmcnt(0)
    v_lshlrev_b32 v18, 16, v47
    v_and_b32 v19, 0xffff0000, v47
    v_fma_f32 v14, v18, s30, v14
    v_fma_f32 v15, v19, s30, v15
    v_fma_f32 v16, v18, s31, v16
    v_fma_f32 v17, v19, s31, v17
    buffer_load_dword v32, v13, s[16:19], s28 offen
    s_add_u32 s28, s28, 9216
    buffer_load_dword v33, v13, s[16:19], s28 offen
    s_add_u32 s28, s28, 9216
    buffer_load_dword v34, v13, s[16:19], s28 offen
    s_add_u32 s28, s28, 9216
    buffer_load_dword v35, v13, s[16:19], s28 offen
    s_add_u32 s28, s28, 9216
    buffer_load_dword v36, v13, s[16:19], s28 offen
    s_add_u32 s28, s28, 9216
    buffer_load_dword v37, v13, s[16:19], s28 offen
    s_add_u32 s28, s28, 9216
    buffer_load_dword v38, v13, s[16:19], s28 offen
    s_add_u32 s28, s28, 9216
    buffer_load_dword v39, v13, s[16:19], s28 offen
    s_add_u32 s28, s28, 9216
    buffer_load_dword v40, v13, s[16:19], s28 offen
    s_add_u32 s28, s28, 9216
    buffer_load_dword v41, v13, s[16:19], s28 offen
    s_add_u32 s28, s28, 9216
    buffer_load_dword v42, v13, s[16:19], s28 offen
    s_add_u32 s28, s28, 9216
    buffer_load_dword v43, v13, s[16:19], s28 offen
    s_add_u32 s28, s28, 9216
    buffer_load_dword v44, v13, s[16:19], s28 offen
    s_add_u32 s28, s28, 9216
    buffer_load_dword v45, v13, s[16:19], s28 offen
    s_add_u32 s28, s28, 9216
    buffer_load_dword v46, v13, s[16:19], s28 offen
    s_add_u32 s28, s28, 9216
    buffer_load_dword v47, v13, s[16:19], s28 offen
    s_add_u32 s28, s28, 9216
    v_readlane_b32 s30, v4, 32
    v_readlane_b32 s31, v6, 32
    s_waitcnt vmcnt(15)
    v_lshlrev_b32 v18, 16, v32
    v_and_b32 v19, 0xffff0000, v32
    v_fma_f32 v14, v18, s30, v14
    v_fma_f32 v15, v19, s30, v15
    v_fma_f32 v16, v18, s31, v16
    v_fma_f32 v17, v19, s31, v17
    v_readlane_b32 s30, v4, 33
    v_readlane_b32 s31, v6, 33
    s_waitcnt vmcnt(14)
    v_lshlrev_b32 v18, 16, v33
    v_and_b32 v19, 0xffff0000, v33
    v_fma_f32 v14, v18, s30, v14
    v_fma_f32 v15, v19, s30, v15
    v_fma_f32 v16, v18, s31, v16
    v_fma_f32 v17, v19, s31, v17
    v_readlane_b32 s30, v4, 34
    v_readlane_b32 s31, v6, 34
    s_waitcnt vmcnt(13)
    v_lshlrev_b32 v18, 16, v34
    v_and_b32 v19, 0xffff0000, v34
    v_fma_f32 v14, v18, s30, v14
    v_fma_f32 v15, v19, s30, v15
    v_fma_f32 v16, v18, s31, v16
    v_fma_f32 v17, v19, s31, v17
    v_readlane_b32 s30, v4, 35
    v_readlane_b32 s31, v6, 35
    s_waitcnt vmcnt(12)
    v_lshlrev_b32 v18, 16, v35
    v_and_b32 v19, 0xffff0000, v35
    v_fma_f32 v14, v18, s30, v14
    v_fma_f32 v15, v19, s30, v15
    v_fma_f32 v16, v18, s31, v16
    v_fma_f32 v17, v19, s31, v17
    v_readlane_b32 s30, v4, 36
    v_readlane_b32 s31, v6, 36
    s_waitcnt vmcnt(11)
    v_lshlrev_b32 v18, 16, v36
    v_and_b32 v19, 0xffff0000, v36
    v_fma_f32 v14, v18, s30, v14
    v_fma_f32 v15, v19, s30, v15
    v_fma_f32 v16, v18, s31, v16
    v_fma_f32 v17, v19, s31, v17
    v_readlane_b32 s30, v4, 37
    v_readlane_b32 s31, v6, 37
    s_waitcnt vmcnt(10)
    v_lshlrev_b32 v18, 16, v37
    v_and_b32 v19, 0xffff0000, v37
    v_fma_f32 v14, v18, s30, v14
    v_fma_f32 v15, v19, s30, v15
    v_fma_f32 v16, v18, s31, v16
    v_fma_f32 v17, v19, s31, v17
    v_readlane_b32 s30, v4, 38
    v_readlane_b32 s31, v6, 38
    s_waitcnt vmcnt(9)
    v_lshlrev_b32 v18, 16, v38
    v_and_b32 v19, 0xffff0000, v38
    v_fma_f32 v14, v18, s30, v14
    v_fma_f32 v15, v19, s30, v15
    v_fma_f32 v16, v18, s31, v16
    v_fma_f32 v17, v19, s31, v17
    v_readlane_b32 s30, v4, 39
    v_readlane_b32 s31, v6, 39
    s_waitcnt vmcnt(8)
    v_lshlrev_b32 v18, 16, v39
    v_and_b32 v19, 0xffff0000, v39
    v_fma_f32 v14, v18, s30, v14
    v_fma_f32 v15, v19, s30, v15
    v_fma_f32 v16, v18, s31, v16
    v_fma_f32 v17, v19, s31, v17
    v_readlane_b32 s30, v4, 40
    v_readlane_b32 s31, v6, 40
    s_waitcnt vmcnt(7)
    v_lshlrev_b32 v18, 16, v40
    v_and_b32 v19, 0xffff0000, v40
    v_fma_f32 v14, v18, s30, v14
    v_fma_f32 v15, v19, s30, v15
    v_fma_f32 v16, v18, s31, v16
    v_fma_f32 v17, v19, s31, v17
    v_readlane_b32 s30, v4, 41
    v_readlane_b32 s31, v6, 41
    s_waitcnt vmcnt(6)
    v_lshlrev_b32 v18, 16, v41
    v_and_b32 v19, 0xffff0000, v41
    v_fma_f32 v14, v18, s30, v14
    v_fma_f32 v15, v19, s30, v15
    v_fma_f32 v16, v18, s31, v16
    v_fma_f32 v17, v19, s31, v17
    v_readlane_b32 s30, v4, 42
    v_readlane_b32 s31, v6, 42
    s_waitcnt vmcnt(5)
    v_lshlrev_b32 v18, 16, v42
    v_and_b32 v19, 0xffff0000, v42
    v_fma_f32 v14, v18, s30, v14
    v_fma_f32 v15, v19, s30, v15
    v_fma_f32 v16, v18, s31, v16
    v_fma_f32 v17, v19, s31, v17
    v_readlane_b32 s30, v4, 43
    v_readlane_b32 s31, v6, 43
    s_waitcnt vmcnt(4)
    v_lshlrev_b32 v18, 16, v43
    v_and_b32 v19, 0xffff0000, v43
    v_fma_f32 v14, v18, s30, v14
    v_fma_f32 v15, v19, s30, v15
    v_fma_f32 v16, v18, s31, v16
    v_fma_f32 v17, v19, s31, v17
    v_readlane_b32 s30, v4, 44
    v_readlane_b32 s31, v6, 44
    s_waitcnt vmcnt(3)
    v_lshlrev_b32 v18, 16, v44
    v_and_b32 v19, 0xffff0000, v44
    v_fma_f32 v14, v18, s30, v14
    v_fma_f32 v15, v19, s30, v15
    v_fma_f32 v16, v18, s31, v16
    v_fma_f32 v17, v19, s31, v17
    v_readlane_b32 s30, v4, 45
    v_readlane_b32 s31, v6, 45
    s_waitcnt vmcnt(2)
    v_lshlrev_b32 v18, 16, v45
    v_and_b32 v19, 0xffff0000, v45
    v_fma_f32 v14, v18, s30, v14
    v_fma_f32 v15, v19, s30, v15
    v_fma_f32 v16, v18, s31, v16
    v_fma_f32 v17, v19, s31, v17
    v_readlane_b32 s30, v4, 46
    v_readlane_b32 s31, v6, 46
    s_waitcnt vmcnt(1)
    v_lshlrev_b32 v18, 16, v46
    v_and_b32 v19, 0xffff0000, v46
    v_fma_f32 v14, v18, s30, v14
    v_fma_f32 v15, v19, s30, v15
    v_fma_f32 v16, v18, s31, v16
    v_fma_f32 v17, v19, s31, v17
    v_readlane_b32 s30, v4, 47
    v_readlane_b32 s31, v6, 47
    s_waitcnt vmcnt(0)
    v_lshlrev_b32 v18, 16, v47
    v_and_b32 v19, 0xffff0000, v47
    v_fma_f32 v14, v18, s30, v14
    v_fma_f32 v15, v19, s30, v15
    v_fma_f32 v16, v18, s31, v16
    v_fma_f32 v17, v19, s31, v17
    buffer_load_dword v32, v13, s[16:19], s28 offen
    s_add_u32 s28, s28, 9216
    buffer_load_dword v33, v13, s[16:19], s28 offen
    s_add_u32 s28, s28, 9216
    buffer_load_dword v34, v13, s[16:19], s28 offen
    s_add_u32 s28, s28, 9216
    buffer_load_dword v35, v13, s[16:19], s28 offen
    s_add_u32 s28, s28, 9216
    buffer_load_dword v36, v13, s[16:19], s28 offen
    s_add_u32 s28, s28, 9216
    buffer_load_dword v37, v13, s[16:19], s28 offen
    s_add_u32 s28, s28, 9216
    buffer_load_dword v38, v13, s[16:19], s28 offen
    s_add_u32 s28, s28, 9216
    buffer_load_dword v39, v13, s[16:19], s28 offen
    s_add_u32 s28, s28, 9216
    buffer_load_dword v40, v13, s[16:19], s28 offen
    s_add_u32 s28, s28, 9216
    buffer_load_dword v41, v13, s[16:19], s28 offen
    s_add_u32 s28, s28, 9216
    buffer_load_dword v42, v13, s[16:19], s28 offen
    s_add_u32 s28, s28, 9216
    buffer_load_dword v43, v13, s[16:19], s28 offen
    s_add_u32 s28, s28, 9216
    buffer_load_dword v44, v13, s[16:19], s28 offen
    s_add_u32 s28, s28, 9216
    buffer_load_dword v45, v13, s[16:19], s28 offen
    s_add_u32 s28, s28, 9216
    buffer_load_dword v46, v13, s[16:19], s28 offen
    s_add_u32 s28, s28, 9216
    buffer_load_dword v47, v13, s[16:19], s28 offen
    s_add_u32 s28, s28, 9216
    v_readlane_b32 s30, v4, 48
    v_readlane_b32 s31, v6, 48
    s_waitcnt vmcnt(15)
    v_lshlrev_b32 v18, 16, v32
    v_and_b32 v19, 0xffff0000, v32
    v_fma_f32 v14, v18, s30, v14
    v_fma_f32 v15, v19, s30, v15
    v_fma_f32 v16, v18, s31, v16
    v_fma_f32 v17, v19, s31, v17
    v_readlane_b32 s30, v4, 49
    v_readlane_b32 s31, v6, 49
    s_waitcnt vmcnt(14)
    v_lshlrev_b32 v18, 16, v33
    v_and_b32 v19, 0xffff0000, v33
    v_fma_f32 v14, v18, s30, v14
    v_fma_f32 v15, v19, s30, v15
    v_fma_f32 v16, v18, s31, v16
    v_fma_f32 v17, v19, s31, v17
    v_readlane_b32 s30, v4, 50
    v_readlane_b32 s31, v6, 50
    s_waitcnt vmcnt(13)
    v_lshlrev_b32 v18, 16, v34
    v_and_b32 v19, 0xffff0000, v34
    v_fma_f32 v14, v18, s30, v14
    v_fma_f32 v15, v19, s30, v15
    v_fma_f32 v16, v18, s31, v16
    v_fma_f32 v17, v19, s31, v17
    v_readlane_b32 s30, v4, 51
    v_readlane_b32 s31, v6, 51
    s_waitcnt vmcnt(12)
    v_lshlrev_b32 v18, 16, v35
    v_and_b32 v19, 0xffff0000, v35
    v_fma_f32 v14, v18, s30, v14
    v_fma_f32 v15, v19, s30, v15
    v_fma_f32 v16, v18, s31, v16
    v_fma_f32 v17, v19, s31, v17
    v_readlane_b32 s30, v4, 52
    v_readlane_b32 s31, v6, 52
    s_waitcnt vmcnt(11)
    v_lshlrev_b32 v18, 16, v36
    v_and_b32 v19, 0xffff0000, v36
    v_fma_f32 v14, v18, s30, v14
    v_fma_f32 v15, v19, s30, v15
    v_fma_f32 v16, v18, s31, v16
    v_fma_f32 v17, v19, s31, v17
    v_readlane_b32 s30, v4, 53
    v_readlane_b32 s31, v6, 53
    s_waitcnt vmcnt(10)
    v_lshlrev_b32 v18, 16, v37
    v_and_b32 v19, 0xffff0000, v37
    v_fma_f32 v14, v18, s30, v14
    v_fma_f32 v15, v19, s30, v15
    v_fma_f32 v16, v18, s31, v16
    v_fma_f32 v17, v19, s31, v17
    v_readlane_b32 s30, v4, 54
    v_readlane_b32 s31, v6, 54
    s_waitcnt vmcnt(9)
    v_lshlrev_b32 v18, 16, v38
    v_and_b32 v19, 0xffff0000, v38
    v_fma_f32 v14, v18, s30, v14
    v_fma_f32 v15, v19, s30, v15
    v_fma_f32 v16, v18, s31, v16
    v_fma_f32 v17, v19, s31, v17
    v_readlane_b32 s30, v4, 55
    v_readlane_b32 s31, v6, 55
    s_waitcnt vmcnt(8)
    v_lshlrev_b32 v18, 16, v39
    v_and_b32 v19, 0xffff0000, v39
    v_fma_f32 v14, v18, s30, v14
    v_fma_f32 v15, v19, s30, v15
    v_fma_f32 v16, v18, s31, v16
    v_fma_f32 v17, v19, s31, v17
    v_readlane_b32 s30, v4, 56
    v_readlane_b32 s31, v6, 56
    s_waitcnt vmcnt(7)
    v_lshlrev_b32 v18, 16, v40
    v_and_b32 v19, 0xffff0000, v40
    v_fma_f32 v14, v18, s30, v14
    v_fma_f32 v15, v19, s30, v15
    v_fma_f32 v16, v18, s31, v16
    v_fma_f32 v17, v19, s31, v17
    v_readlane_b32 s30, v4, 57
    v_readlane_b32 s31, v6, 57
    s_waitcnt vmcnt(6)
    v_lshlrev_b32 v18, 16, v41
    v_and_b32 v19, 0xffff0000, v41
    v_fma_f32 v14, v18, s30, v14
    v_fma_f32 v15, v19, s30, v15
    v_fma_f32 v16, v18, s31, v16
    v_fma_f32 v17, v19, s31, v17
    v_readlane_b32 s30, v4, 58
    v_readlane_b32 s31, v6, 58
    s_waitcnt vmcnt(5)
    v_lshlrev_b32 v18, 16, v42
    v_and_b32 v19, 0xffff0000, v42
    v_fma_f32 v14, v18, s30, v14
    v_fma_f32 v15, v19, s30, v15
    v_fma_f32 v16, v18, s31, v16
    v_fma_f32 v17, v19, s31, v17
    v_readlane_b32 s30, v4, 59
    v_readlane_b32 s31, v6, 59
    s_waitcnt vmcnt(4)
    v_lshlrev_b32 v18, 16, v43
    v_and_b32 v19, 0xffff0000, v43
    v_fma_f32 v14, v18, s30, v14
    v_fma_f32 v15, v19, s30, v15
    v_fma_f32 v16, v18, s31, v16
    v_fma_f32 v17, v19, s31, v17
    v_readlane_b32 s30, v4, 60
    v_readlane_b32 s31, v6, 60
    s_waitcnt vmcnt(3)
    v_lshlrev_b32 v18, 16, v44
    v_and_b32 v19, 0xffff0000, v44
    v_fma_f32 v14, v18, s30, v14
    v_fma_f32 v15, v19, s30, v15
    v_fma_f32 v16, v18, s31, v16
    v_fma_f32 v17, v19, s31, v17
    v_readlane_b32 s30, v4, 61
    v_readlane_b32 s31, v6, 61
    s_waitcnt vmcnt(2)
    v_lshlrev_b32 v18, 16, v45
    v_and_b32 v19, 0xffff0000, v45
    v_fma_f32 v14, v18, s30, v14
    v_fma_f32 v15, v19, s30, v15
    v_fma_f32 v16, v18, s31, v16
    v_fma_f32 v17, v19, s31, v17
    v_readlane_b32 s30, v4, 62
    v_readlane_b32 s31, v6, 62
    s_waitcnt vmcnt(1)
    v_lshlrev_b32 v18, 16, v46
    v_and_b32 v19, 0xffff0000, v46
    v_fma_f32 v14, v18, s30, v14
    v_fma_f32 v15, v19, s30, v15
    v_fma_f32 v16, v18, s31, v16
    v_fma_f32 v17, v19, s31, v17
    v_readlane_b32 s30, v4, 63
    v_readlane_b32 s31, v6, 63
    s_waitcnt vmcnt(0)
    v_lshlrev_b32 v18, 16, v47
    v_and_b32 v19, 0xffff0000, v47
    v_fma_f32 v14, v18, s30, v14
    v_fma_f32 v15, v19, s30, v15
    v_fma_f32 v16, v18, s31, v16
    v_fma_f32 v17, v19, s31, v17
    buffer_load_dword v32, v13, s[16:19], s28 offen
    s_add_u32 s28, s28, 9216
    buffer_load_dword v33, v13, s[16:19], s28 offen
    s_add_u32 s28, s28, 9216
    buffer_load_dword v34, v13, s[16:19], s28 offen
    s_add_u32 s28, s28, 9216
    buffer_load_dword v35, v13, s[16:19], s28 offen
    s_add_u32 s28, s28, 9216
    buffer_load_dword v36, v13, s[16:19], s28 offen
    s_add_u32 s28, s28, 9216
    buffer_load_dword v37, v13, s[16:19], s28 offen
    s_add_u32 s28, s28, 9216
    buffer_load_dword v38, v13, s[16:19], s28 offen
    s_add_u32 s28, s28, 9216
    buffer_load_dword v39, v13, s[16:19], s28 offen
    s_add_u32 s28, s28, 9216
    buffer_load_dword v40, v13, s[16:19], s28 offen
    s_add_u32 s28, s28, 9216
    buffer_load_dword v41, v13, s[16:19], s28 offen
    s_add_u32 s28, s28, 9216
    buffer_load_dword v42, v13, s[16:19], s28 offen
    s_add_u32 s28, s28, 9216
    buffer_load_dword v43, v13, s[16:19], s28 offen
    s_add_u32 s28, s28, 9216
    buffer_load_dword v44, v13, s[16:19], s28 offen
    s_add_u32 s28, s28, 9216
    buffer_load_dword v45, v13, s[16:19], s28 offen
    s_add_u32 s28, s28, 9216
    buffer_load_dword v46, v13, s[16:19], s28 offen
    s_add_u32 s28, s28, 9216
    buffer_load_dword v47, v13, s[16:19], s28 offen
    s_add_u32 s28, s28, 9216
    v_readlane_b32 s30, v5, 0
    v_readlane_b32 s31, v7, 0
    s_waitcnt vmcnt(15)
    v_lshlrev_b32 v18, 16, v32
    v_and_b32 v19, 0xffff0000, v32
    v_fma_f32 v14, v18, s30, v14
    v_fma_f32 v15, v19, s30, v15
    v_fma_f32 v16, v18, s31, v16
    v_fma_f32 v17, v19, s31, v17
    v_readlane_b32 s30, v5, 1
    v_readlane_b32 s31, v7, 1
    s_waitcnt vmcnt(14)
    v_lshlrev_b32 v18, 16, v33
    v_and_b32 v19, 0xffff0000, v33
    v_fma_f32 v14, v18, s30, v14
    v_fma_f32 v15, v19, s30, v15
    v_fma_f32 v16, v18, s31, v16
    v_fma_f32 v17, v19, s31, v17
    v_readlane_b32 s30, v5, 2
    v_readlane_b32 s31, v7, 2
    s_waitcnt vmcnt(13)
    v_lshlrev_b32 v18, 16, v34
    v_and_b32 v19, 0xffff0000, v34
    v_fma_f32 v14, v18, s30, v14
    v_fma_f32 v15, v19, s30, v15
    v_fma_f32 v16, v18, s31, v16
    v_fma_f32 v17, v19, s31, v17
    v_readlane_b32 s30, v5, 3
    v_readlane_b32 s31, v7, 3
    s_waitcnt vmcnt(12)
    v_lshlrev_b32 v18, 16, v35
    v_and_b32 v19, 0xffff0000, v35
    v_fma_f32 v14, v18, s30, v14
    v_fma_f32 v15, v19, s30, v15
    v_fma_f32 v16, v18, s31, v16
    v_fma_f32 v17, v19, s31, v17
    v_readlane_b32 s30, v5, 4
    v_readlane_b32 s31, v7, 4
    s_waitcnt vmcnt(11)
    v_lshlrev_b32 v18, 16, v36
    v_and_b32 v19, 0xffff0000, v36
    v_fma_f32 v14, v18, s30, v14
    v_fma_f32 v15, v19, s30, v15
    v_fma_f32 v16, v18, s31, v16
    v_fma_f32 v17, v19, s31, v17
    v_readlane_b32 s30, v5, 5
    v_readlane_b32 s31, v7, 5
    s_waitcnt vmcnt(10)
    v_lshlrev_b32 v18, 16, v37
    v_and_b32 v19, 0xffff0000, v37
    v_fma_f32 v14, v18, s30, v14
    v_fma_f32 v15, v19, s30, v15
    v_fma_f32 v16, v18, s31, v16
    v_fma_f32 v17, v19, s31, v17
    v_readlane_b32 s30, v5, 6
    v_readlane_b32 s31, v7, 6
    s_waitcnt vmcnt(9)
    v_lshlrev_b32 v18, 16, v38
    v_and_b32 v19, 0xffff0000, v38
    v_fma_f32 v14, v18, s30, v14
    v_fma_f32 v15, v19, s30, v15
    v_fma_f32 v16, v18, s31, v16
    v_fma_f32 v17, v19, s31, v17
    v_readlane_b32 s30, v5, 7
    v_readlane_b32 s31, v7, 7
    s_waitcnt vmcnt(8)
    v_lshlrev_b32 v18, 16, v39
    v_and_b32 v19, 0xffff0000, v39
    v_fma_f32 v14, v18, s30, v14
    v_fma_f32 v15, v19, s30, v15
    v_fma_f32 v16, v18, s31, v16
    v_fma_f32 v17, v19, s31, v17
    v_readlane_b32 s30, v5, 8
    v_readlane_b32 s31, v7, 8
    s_waitcnt vmcnt(7)
    v_lshlrev_b32 v18, 16, v40
    v_and_b32 v19, 0xffff0000, v40
    v_fma_f32 v14, v18, s30, v14
    v_fma_f32 v15, v19, s30, v15
    v_fma_f32 v16, v18, s31, v16
    v_fma_f32 v17, v19, s31, v17
    v_readlane_b32 s30, v5, 9
    v_readlane_b32 s31, v7, 9
    s_waitcnt vmcnt(6)
    v_lshlrev_b32 v18, 16, v41
    v_and_b32 v19, 0xffff0000, v41
    v_fma_f32 v14, v18, s30, v14
    v_fma_f32 v15, v19, s30, v15
    v_fma_f32 v16, v18, s31, v16
    v_fma_f32 v17, v19, s31, v17
    v_readlane_b32 s30, v5, 10
    v_readlane_b32 s31, v7, 10
    s_waitcnt vmcnt(5)
    v_lshlrev_b32 v18, 16, v42
    v_and_b32 v19, 0xffff0000, v42
    v_fma_f32 v14, v18, s30, v14
    v_fma_f32 v15, v19, s30, v15
    v_fma_f32 v16, v18, s31, v16
    v_fma_f32 v17, v19, s31, v17
    v_readlane_b32 s30, v5, 11
    v_readlane_b32 s31, v7, 11
    s_waitcnt vmcnt(4)
    v_lshlrev_b32 v18, 16, v43
    v_and_b32 v19, 0xffff0000, v43
    v_fma_f32 v14, v18, s30, v14
    v_fma_f32 v15, v19, s30, v15
    v_fma_f32 v16, v18, s31, v16
    v_fma_f32 v17, v19, s31, v17
    v_readlane_b32 s30, v5, 12
    v_readlane_b32 s31, v7, 12
    s_waitcnt vmcnt(3)
    v_lshlrev_b32 v18, 16, v44
    v_and_b32 v19, 0xffff0000, v44
    v_fma_f32 v14, v18, s30, v14
    v_fma_f32 v15, v19, s30, v15
    v_fma_f32 v16, v18, s31, v16
    v_fma_f32 v17, v19, s31, v17
    v_readlane_b32 s30, v5, 13
    v_readlane_b32 s31, v7, 13
    s_waitcnt vmcnt(2)
    v_lshlrev_b32 v18, 16, v45
    v_and_b32 v19, 0xffff0000, v45
    v_fma_f32 v14, v18, s30, v14
    v_fma_f32 v15, v19, s30, v15
    v_fma_f32 v16, v18, s31, v16
    v_fma_f32 v17, v19, s31, v17
    v_readlane_b32 s30, v5, 14
    v_readlane_b32 s31, v7, 14
    s_waitcnt vmcnt(1)
    v_lshlrev_b32 v18, 16, v46
    v_and_b32 v19, 0xffff0000, v46
    v_fma_f32 v14, v18, s30, v14
    v_fma_f32 v15, v19, s30, v15
    v_fma_f32 v16, v18, s31, v16
    v_fma_f32 v17, v19, s31, v17
    v_readlane_b32 s30, v5, 15
    v_readlane_b32 s31, v7, 15
    s_waitcnt vmcnt(0)
    v_lshlrev_b32 v18, 16, v47
    v_and_b32 v19, 0xffff0000, v47
    v_fma_f32 v14, v18, s30, v14
    v_fma_f32 v15, v19, s30, v15
    v_fma_f32 v16, v18, s31, v16
    v_fma_f32 v17, v19, s31, v17
    buffer_load_dword v32, v13, s[16:19], s28 offen
    s_add_u32 s28, s28, 9216
    buffer_load_dword v33, v13, s[16:19], s28 offen
    s_add_u32 s28, s28, 9216
    buffer_load_dword v34, v13, s[16:19], s28 offen
    s_add_u32 s28, s28, 9216
    buffer_load_dword v35, v13, s[16:19], s28 offen
    s_add_u32 s28, s28, 9216
    buffer_load_dword v36, v13, s[16:19], s28 offen
    s_add_u32 s28, s28, 9216
    buffer_load_dword v37, v13, s[16:19], s28 offen
    s_add_u32 s28, s28, 9216
    buffer_load_dword v38, v13, s[16:19], s28 offen
    s_add_u32 s28, s28, 9216
    buffer_load_dword v39, v13, s[16:19], s28 offen
    s_add_u32 s28, s28, 9216
    buffer_load_dword v40, v13, s[16:19], s28 offen
    s_add_u32 s28, s28, 9216
    buffer_load_dword v41, v13, s[16:19], s28 offen
    s_add_u32 s28, s28, 9216
    buffer_load_dword v42, v13, s[16:19], s28 offen
    s_add_u32 s28, s28, 9216
    buffer_load_dword v43, v13, s[16:19], s28 offen
    s_add_u32 s28, s28, 9216
    buffer_load_dword v44, v13, s[16:19], s28 offen
    s_add_u32 s28, s28, 9216
    buffer_load_dword v45, v13, s[16:19], s28 offen
    s_add_u32 s28, s28, 9216
    buffer_load_dword v46, v13, s[16:19], s28 offen
    s_add_u32 s28, s28, 9216
    buffer_load_dword v47, v13, s[16:19], s28 offen
    s_add_u32 s28, s28, 9216
    v_readlane_b32 s30, v5, 16
    v_readlane_b32 s31, v7, 16
    s_waitcnt vmcnt(15)
    v_lshlrev_b32 v18, 16, v32
    v_and_b32 v19, 0xffff0000, v32
    v_fma_f32 v14, v18, s30, v14
    v_fma_f32 v15, v19, s30, v15
    v_fma_f32 v16, v18, s31, v16
    v_fma_f32 v17, v19, s31, v17
    v_readlane_b32 s30, v5, 17
    v_readlane_b32 s31, v7, 17
    s_waitcnt vmcnt(14)
    v_lshlrev_b32 v18, 16, v33
    v_and_b32 v19, 0xffff0000, v33
    v_fma_f32 v14, v18, s30, v14
    v_fma_f32 v15, v19, s30, v15
    v_fma_f32 v16, v18, s31, v16
    v_fma_f32 v17, v19, s31, v17
    v_readlane_b32 s30, v5, 18
    v_readlane_b32 s31, v7, 18
    s_waitcnt vmcnt(13)
    v_lshlrev_b32 v18, 16, v34
    v_and_b32 v19, 0xffff0000, v34
    v_fma_f32 v14, v18, s30, v14
    v_fma_f32 v15, v19, s30, v15
    v_fma_f32 v16, v18, s31, v16
    v_fma_f32 v17, v19, s31, v17
    v_readlane_b32 s30, v5, 19
    v_readlane_b32 s31, v7, 19
    s_waitcnt vmcnt(12)
    v_lshlrev_b32 v18, 16, v35
    v_and_b32 v19, 0xffff0000, v35
    v_fma_f32 v14, v18, s30, v14
    v_fma_f32 v15, v19, s30, v15
    v_fma_f32 v16, v18, s31, v16
    v_fma_f32 v17, v19, s31, v17
    v_readlane_b32 s30, v5, 20
    v_readlane_b32 s31, v7, 20
    s_waitcnt vmcnt(11)
    v_lshlrev_b32 v18, 16, v36
    v_and_b32 v19, 0xffff0000, v36
    v_fma_f32 v14, v18, s30, v14
    v_fma_f32 v15, v19, s30, v15
    v_fma_f32 v16, v18, s31, v16
    v_fma_f32 v17, v19, s31, v17
    v_readlane_b32 s30, v5, 21
    v_readlane_b32 s31, v7, 21
    s_waitcnt vmcnt(10)
    v_lshlrev_b32 v18, 16, v37
    v_and_b32 v19, 0xffff0000, v37
    v_fma_f32 v14, v18, s30, v14
    v_fma_f32 v15, v19, s30, v15
    v_fma_f32 v16, v18, s31, v16
    v_fma_f32 v17, v19, s31, v17
    v_readlane_b32 s30, v5, 22
    v_readlane_b32 s31, v7, 22
    s_waitcnt vmcnt(9)
    v_lshlrev_b32 v18, 16, v38
    v_and_b32 v19, 0xffff0000, v38
    v_fma_f32 v14, v18, s30, v14
    v_fma_f32 v15, v19, s30, v15
    v_fma_f32 v16, v18, s31, v16
    v_fma_f32 v17, v19, s31, v17
    v_readlane_b32 s30, v5, 23
    v_readlane_b32 s31, v7, 23
    s_waitcnt vmcnt(8)
    v_lshlrev_b32 v18, 16, v39
    v_and_b32 v19, 0xffff0000, v39
    v_fma_f32 v14, v18, s30, v14
    v_fma_f32 v15, v19, s30, v15
    v_fma_f32 v16, v18, s31, v16
    v_fma_f32 v17, v19, s31, v17
    v_readlane_b32 s30, v5, 24
    v_readlane_b32 s31, v7, 24
    s_waitcnt vmcnt(7)
    v_lshlrev_b32 v18, 16, v40
    v_and_b32 v19, 0xffff0000, v40
    v_fma_f32 v14, v18, s30, v14
    v_fma_f32 v15, v19, s30, v15
    v_fma_f32 v16, v18, s31, v16
    v_fma_f32 v17, v19, s31, v17
    v_readlane_b32 s30, v5, 25
    v_readlane_b32 s31, v7, 25
    s_waitcnt vmcnt(6)
    v_lshlrev_b32 v18, 16, v41
    v_and_b32 v19, 0xffff0000, v41
    v_fma_f32 v14, v18, s30, v14
    v_fma_f32 v15, v19, s30, v15
    v_fma_f32 v16, v18, s31, v16
    v_fma_f32 v17, v19, s31, v17
    v_readlane_b32 s30, v5, 26
    v_readlane_b32 s31, v7, 26
    s_waitcnt vmcnt(5)
    v_lshlrev_b32 v18, 16, v42
    v_and_b32 v19, 0xffff0000, v42
    v_fma_f32 v14, v18, s30, v14
    v_fma_f32 v15, v19, s30, v15
    v_fma_f32 v16, v18, s31, v16
    v_fma_f32 v17, v19, s31, v17
    v_readlane_b32 s30, v5, 27
    v_readlane_b32 s31, v7, 27
    s_waitcnt vmcnt(4)
    v_lshlrev_b32 v18, 16, v43
    v_and_b32 v19, 0xffff0000, v43
    v_fma_f32 v14, v18, s30, v14
    v_fma_f32 v15, v19, s30, v15
    v_fma_f32 v16, v18, s31, v16
    v_fma_f32 v17, v19, s31, v17
    v_readlane_b32 s30, v5, 28
    v_readlane_b32 s31, v7, 28
    s_waitcnt vmcnt(3)
    v_lshlrev_b32 v18, 16, v44
    v_and_b32 v19, 0xffff0000, v44
    v_fma_f32 v14, v18, s30, v14
    v_fma_f32 v15, v19, s30, v15
    v_fma_f32 v16, v18, s31, v16
    v_fma_f32 v17, v19, s31, v17
    v_readlane_b32 s30, v5, 29
    v_readlane_b32 s31, v7, 29
    s_waitcnt vmcnt(2)
    v_lshlrev_b32 v18, 16, v45
    v_and_b32 v19, 0xffff0000, v45
    v_fma_f32 v14, v18, s30, v14
    v_fma_f32 v15, v19, s30, v15
    v_fma_f32 v16, v18, s31, v16
    v_fma_f32 v17, v19, s31, v17
    v_readlane_b32 s30, v5, 30
    v_readlane_b32 s31, v7, 30
    s_waitcnt vmcnt(1)
    v_lshlrev_b32 v18, 16, v46
    v_and_b32 v19, 0xffff0000, v46
    v_fma_f32 v14, v18, s30, v14
    v_fma_f32 v15, v19, s30, v15
    v_fma_f32 v16, v18, s31, v16
    v_fma_f32 v17, v19, s31, v17
    v_readlane_b32 s30, v5, 31
    v_readlane_b32 s31, v7, 31
    s_waitcnt vmcnt(0)
    v_lshlrev_b32 v18, 16, v47
    v_and_b32 v19, 0xffff0000, v47
    v_fma_f32 v14, v18, s30, v14
    v_fma_f32 v15, v19, s30, v15
    v_fma_f32 v16, v18, s31, v16
    v_fma_f32 v17, v19, s31, v17
    v_lshlrev_b32 v20, 4, v0
    ds_write_b128 v20, v[14:17]
    s_waitcnt lgkmcnt(0)
    s_barrier
    s_cmp_lg_u32 s3, 0
    s_cbranch_scc1 L_dit_mod_kernel_1
    ds_read_b128 v[24:27], v20 offset:1024
    ds_read_b128 v[28:31], v20 offset:2048
    ds_read_b128 v[32:35], v20 offset:3072
    ds_read_b128 v[36:39], v20 offset:4096
    ds_read_b128 v[40:43], v20 offset:5120
    ds_read_b128 v[44:47], v20 offset:6144
    ds_read_b128 v[48:51], v20 offset:7168
    s_waitcnt lgkmcnt(0)
    v_add_f32 v14, v14, v24
    v_add_f32 v15, v15, v25
    v_add_f32 v16, v16, v26
    v_add_f32 v17, v17, v27
    v_add_f32 v14, v14, v28
    v_add_f32 v15, v15, v29
    v_add_f32 v16, v16, v30
    v_add_f32 v17, v17, v31
    v_add_f32 v14, v14, v32
    v_add_f32 v15, v15, v33
    v_add_f32 v16, v16, v34
    v_add_f32 v17, v17, v35
    v_add_f32 v14, v14, v36
    v_add_f32 v15, v15, v37
    v_add_f32 v16, v16, v38
    v_add_f32 v17, v17, v39
    v_add_f32 v14, v14, v40
    v_add_f32 v15, v15, v41
    v_add_f32 v16, v16, v42
    v_add_f32 v17, v17, v43
    v_add_f32 v14, v14, v44
    v_add_f32 v15, v15, v45
    v_add_f32 v16, v16, v46
    v_add_f32 v17, v17, v47
    v_add_f32 v14, v14, v48
    v_add_f32 v15, v15, v49
    v_add_f32 v16, v16, v50
    v_add_f32 v17, v17, v51
    v_cvt_pk_bf16_f32 v12, v14, v15
    v_lshlrev_b32 v14, 16, v12
    v_and_b32 v15, 0xffff0000, v12
    v_cvt_pk_bf16_f32 v12, v16, v17
    v_lshlrev_b32 v16, 16, v12
    v_and_b32 v17, 0xffff0000, v12
    s_lshl_b32 s26, s2, 9
    v_lshlrev_b32 v13, 3, v2
    v_add_u32 v13, s26, v13
    buffer_store_dwordx2 v[14:15], v13, s[20:23], 0 offen
    v_add_u32 v13, 18432, v13
    buffer_store_dwordx2 v[16:17], v13, s[20:23], 0 offen
    s_waitcnt vmcnt(0)
L_dit_mod_kernel_1:
    s_endpgm
.section .rodata,"a"
.p2align 6
.amdhsa_kernel dit_mod_kernel
  .amdhsa_next_free_vgpr 64
  .amdhsa_next_free_sgpr 100
  .amdhsa_accum_offset 64
  .amdhsa_group_segment_fixed_size 0
  .amdhsa_kernarg_size 80
  .amdhsa_user_sgpr_count 2
  .amdhsa_user_sgpr_kernarg_segment_ptr 1
  .amdhsa_system_sgpr_workgroup_id_x 1
.end_amdhsa_kernel
.text
.globl dit_ln1_kernel
.p2align 8
.type dit_ln1_kernel,@function
dit_ln1_kernel:
    s_cmp_ge_u32 s2, 512
    s_cbranch_scc1 L_dit_ln1_kernel_1
    s_load_dwordx2 s[4:5], s[0:1], 0
    s_load_dwordx2 s[8:9], s[0:1], 72
    v_lshrrev_b32 v1, 6, v0
    v_and_b32 v2, 63, v0
    s_nop 0
    v_readfirstlane_b32 s3, v1
    s_waitcnt lgkmcnt(0)
    s_mov_b32 s12, s4
    s_mov_b32 s13, s5
    s_mov_b32 s14, 3145728
    s_mov_b32 s15, 0x00020000
    s_mov_b32 s16, s8
    s_mov_b32 s17, s9
    s_mov_b32 s18, 36864
    s_mov_b32 s19, 0x00020000
    s_add_u32 s20, s8, 1048576
    s_addc_u32 s21, s9, 0
    s_mov_b32 s22, 3145728
    s_mov_b32 s23, 0x00020000
    s_lshl_b32 s24, s2, 2
    s_add_u32 s24, s24, s3
    s_lshr_b32 s25, s24, 10
    s_mul_i32 s26, s24, 1536
    v_lshlrev_b32 v3, 3, v2
    buffer_load_dwordx2 v[4:5], v3, s[12:15], s26 offen
    buffer_load_dwordx2 v[6:7], v3, s[12:15], s26 offen offset:512
    buffer_load_dwordx2 v[8:9], v3, s[12:15], s26 offen offset:1024
    s_mul_i32 s27, s25, 18432
    s_add_u32 s28, s27, 0
    s_add_u32 s29, s27, 3072
    v_lshlrev_b32 v10, 4, v2
    buffer_load_dwordx4 v[40:43], v10, s[16:19], s28 offen offset:0
    buffer_load_dwordx4 v[44:47], v10, s[16:19], s28 offen offset:1024
    buffer_load_dwordx4 v[48:51], v10, s[16:19], s28 offen offset:2048
    buffer_load_dwordx4 v[52:55], v10, s[16:19], s29 offen offset:0
    buffer_load_dwordx4 v[56:59], v10, s[16:19], s29 offen offset:1024
    buffer_load_dwordx4 v[60:63], v10, s[16:19], s29 offen offset:2048
    v_xor_b32 v64, 1, v2
    v_lshlrev_b32 v64, 2, v64
    v_xor_b32 v65, 2, v2
    v_lshlrev_b32 v65, 2, v65
    v_xor_b32 v66, 4, v2
    v_lshlrev_b32 v66, 2, v66
    v_xor_b32 v67, 8, v2
    v_lshlrev_b32 v67, 2, v67
    v_xor_b32 v68, 16, v2
    v_lshlrev_b32 v68, 2, v68
    v_xor_b32 v69, 32, v2
    v_lshlrev_b32 v69, 2, v69
    s_waitcnt vmcnt(6)
    v_lshlrev_b32 v12, 16, v4
    v_and_b32 v13, 0xffff0000, v4
    v_lshlrev_b32 v14, 16, v5
    v_and_b32 v15, 0xffff0000, v5
    v_lshlrev_b32 v16, 16, v6
    v_and_b32 v17, 0xffff0000, v6
    v_lshlrev_b32 v18, 16, v7
    v_and_b32 v19, 0xffff0000, v7
    v_lshlrev_b32 v20, 16, v8
    v_and_b32 v21, 0xffff0000, v8
    v_lshlrev_b32 v22, 16, v9
    v_and_b32 v23, 0xffff0000, v9
    v_add_f32 v24, v12, v13
    v_add_f32 v24, v24, v14
    v_add_f32 v24, v24, v15
    v_add_f32 v24, v24, v16
    v_add_f32 v24, v24, v17
    v_add_f32 v24, v24, v18
    v_add_f32 v24, v24, v19
    v_add_f32 v24, v24, v20
    v_add_f32 v24, v24, v21
    v_add_f32 v24, v24, v22
    v_add_f32 v24, v24, v23
    ds_bpermute_b32 v25, v64, v24
    s_waitcnt lgkmcnt(0)
    v_add_f32 v24, v24, v25
    ds_bpermute_b32 v25, v65, v24
    s_waitcnt lgkmcnt(0)
    v_add_f32 v24, v24, v25
    ds_bpermute_b32 v25, v66, v24
    s_waitcnt lgkmcnt(0)
    v_add_f32 v24, v24, v25
    ds_bpermute_b32 v25, v67, v24
    s_waitcnt lgkmcnt(0)
    v_add_f32 v24, v24, v25
    ds_bpermute_b32 v25, v68, v24
    s_waitcnt lgkmcnt(0)
    v_add_f32 v24, v24, v25
    ds_bpermute_b32 v25, v69, v24
    s_waitcnt lgkmcnt(0)
    v_add_f32 v24, v24, v25
    v_mul_f32 v24, 0x3aaaaaab, v24
    v_sub_f32 v26, v12, v24
    v_mul_f32 v27, v26, v26
    v_sub_f32 v26, v13, v24
    v_fmac_f32 v27, v26, v26
    v_sub_f32 v26, v14, v24
    v_fmac_f32 v27, v26, v26
    v_sub_f32 v26, v15, v24
    v_fmac_f32 v27, v26, v26
    v_sub_f32 v26, v16, v24
    v_fmac_f32 v27, v26, v26
    v_sub_f32 v26, v17, v24
    v_fmac_f32 v27, v26, v26
    v_sub_f32 v26, v18, v24
    v_fmac_f32 v27, v26, v26
    v_sub_f32 v26, v19, v24
    v_fmac_f32 v27, v26, v26
    v_sub_f32 v26, v20, v24
    v_fmac_f32 v27, v26, v26
    v_sub_f32 v26, v21, v24
    v_fmac_f32 v27, v26, v26
    v_sub_f32 v26, v22, v24
    v_fmac_f32 v27, v26, v26
    v_sub_f32 v26, v23, v24
    v_fmac_f32 v27, v26, v26
    ds_bpermute_b32 v25, v64, v27
    s_waitcnt lgkmcnt(0)
    v_add_f32 v27, v27, v25
    ds_bpermute_b32 v25, v65, v27
    s_waitcnt lgkmcnt(0)
    v_add_f32 v27, v27, v25
    ds_bpermute_b32 v25, v66, v27
    s_waitcnt lgkmcnt(0)
    v_add_f32 v27, v27, v25
    ds_bpermute_b32 v25, v67, v27
    s_waitcnt lgkmcnt(0)
    v_add_f32 v27, v27, v25
    ds_bpermute_b32 v25, v68, v27
    s_waitcnt lgkmcnt(0)
    v_add_f32 v27, v27, v25
    ds_bpermute_b32 v25, v69, v27
    s_waitcnt lgkmcnt(0)
    v_add_f32 v27, v27, v25
    v_mul_f32 v27, 0x3aaaaaab, v27
    v_cvt_pk_bf16_f32 v25, v24, v27
    v_lshlrev_b32 v24, 16, v25
    v_and_b32 v27, 0xffff0000, v25
    v_add_f32 v27, 0x3727c5ac, v27
    v_mov_b32 v26, 0
    v_cvt_pk_bf16_f32 v25, v27, v26
    v_lshlrev_b32 v27, 16, v25
    v_and_b32 v26, 0xffff0000, v25
    v_sqrt_f32 v27, v27
    s_nop 0
    v_cvt_pk_bf16_f32 v25, v27, v26
    v_lshlrev_b32 v27, 16, v25
    v_and_b32 v26, 0xffff0000, v25
    v_rcp_f32 v27, v27
    v_sub_f32 v12, v12, v24
    v_sub_f32 v13, v13, v24
    v_sub_f32 v14, v14, v24
    v_sub_f32 v15, v15, v24
    v_sub_f32 v16, v16, v24
    v_sub_f32 v17, v17, v24
    v_sub_f32 v18, v18, v24
    v_sub_f32 v19, v19, v24
    v_sub_f32 v20, v20, v24
    v_sub_f32 v21, v21, v24
    v_sub_f32 v22, v22, v24
    v_sub_f32 v23, v23, v24
    v_cvt_pk_bf16_f32 v25, v12, v13
    v_lshlrev_b32 v12, 16, v25
    v_and_b32 v13, 0xffff0000, v25
    v_cvt_pk_bf16_f32 v25, v14, v15
    v_lshlrev_b32 v14, 16, v25
    v_and_b32 v15, 0xffff0000, v25
    v_cvt_pk_bf16_f32 v25, v16, v17
    v_lshlrev_b32 v16, 16, v25
    v_and_b32 v17, 0xffff0000, v25
    v_cvt_pk_bf16_f32 v25, v18, v19
    v_lshlrev_b32 v18, 16, v25
    v_and_b32 v19, 0xffff0000, v25
    v_cvt_pk_bf16_f32 v25, v20, v21
    v_lshlrev_b32 v20, 16, v25
    v_and_b32 v21, 0xffff0000, v25
    v_cvt_pk_bf16_f32 v25, v22, v23
    v_lshlrev_b32 v22, 16, v25
    v_and_b32 v23, 0xffff0000, v25
    v_mul_f32 v12, v12, v27
    v_mul_f32 v13, v13, v27
    v_mul_f32 v14, v14, v27
    v_mul_f32 v15, v15, v27
    v_mul_f32 v16, v16, v27
    v_mul_f32 v17, v17, v27
    v_mul_f32 v18, v18, v27
    v_mul_f32 v19, v19, v27
    v_mul_f32 v20, v20, v27
    v_mul_f32 v21, v21, v27
    v_mul_f32 v22, v22, v27
    v_mul_f32 v23, v23, v27
    v_cvt_pk_bf16_f32 v25, v12, v13
    v_lshlrev_b32 v12, 16, v25
    v_and_b32 v13, 0xffff0000, v25
    v_cvt_pk_bf16_f32 v25, v14, v15
    v_lshlrev_b32 v14, 16, v25
    v_and_b32 v15, 0xffff0000, v25
    v_cvt_pk_bf16_f32 v25, v16, v17
    v_lshlrev_b32 v16, 16, v25
    v_and_b32 v17, 0xffff0000, v25
    v_cvt_pk_bf16_f32 v25, v18, v19
    v_lshlrev_b32 v18, 16, v25
    v_and_b32 v19, 0xffff0000, v25
    v_cvt_pk_bf16_f32 v25, v20, v21
    v_lshlrev_b32 v20, 16, v25
    v_and_b32 v21, 0xffff0000, v25
    v_cvt_pk_bf16_f32 v25, v22, v23
    v_lshlrev_b32 v22, 16, v25
    v_and_b32 v23, 0xffff0000, v25
    s_waitcnt vmcnt(0)
    v_add_f32 v52, 1.0, v52
    v_add_f32 v53, 1.0, v53
    v_add_f32 v54, 1.0, v54
    v_add_f32 v55, 1.0, v55
    v_add_f32 v56, 1.0, v56
    v_add_f32 v57, 1.0, v57
    v_add_f32 v58, 1.0, v58
    v_add_f32 v59, 1.0, v59
    v_add_f32 v60, 1.0, v60
    v_add_f32 v61, 1.0, v61
    v_add_f32 v62, 1.0, v62
    v_add_f32 v63, 1.0, v63
    v_cvt_pk_bf16_f32 v25, v52, v53
    v_lshlrev_b32 v52, 16, v25
    v_and_b32 v53, 0xffff0000, v25
    v_cvt_pk_bf16_f32 v25, v54, v55
    v_lshlrev_b32 v54, 16, v25
    v_and_b32 v55, 0xffff0000, v25
    v_cvt_pk_bf16_f32 v25, v56, v57
    v_lshlrev_b32 v56, 16, v25
    v_and_b32 v57, 0xffff0000, v25
    v_cvt_pk_bf16_f32 v25, v58, v59
    v_lshlrev_b32 v58, 16, v25
    v_and_b32 v59, 0xffff0000, v25
    v_cvt_pk_bf16_f32 v25, v60, v61
    v_lshlrev_b32 v60, 16, v25
    v_and_b32 v61, 0xffff0000, v25
    v_cvt_pk_bf16_f32 v25, v62, v63
    v_lshlrev_b32 v62, 16, v25
    v_and_b32 v63, 0xffff0000, v25
    v_mul_f32 v12, v12, v52
    v_mul_f32 v13, v13, v53
    v_mul_f32 v14, v14, v54
    v_mul_f32 v15, v15, v55
    v_mul_f32 v16, v16, v56
    v_mul_f32 v17, v17, v57
    v_mul_f32 v18, v18, v58
    v_mul_f32 v19, v19, v59
    v_mul_f32 v20, v20, v60
    v_mul_f32 v21, v21, v61
    v_mul_f32 v22, v22, v62
    v_mul_f32 v23, v23, v63
    v_cvt_pk_bf16_f32 v25, v12, v13
    v_lshlrev_b32 v12, 16, v25
    v_and_b32 v13, 0xffff0000, v25
    v_cvt_pk_bf16_f32 v25, v14, v15
    v_lshlrev_b32 v14, 16, v25
    v_and_b32 v15, 0xffff0000, v25
    v_cvt_pk_bf16_f32 v25, v16, v17
    v_lshlrev_b32 v16, 16, v25
    v_and_b32 v17, 0xffff0000, v25
    v_cvt_pk_bf16_f32 v25, v18, v19
    v_lshlrev_b32 v18, 16, v25
    v_and_b32 v19, 0xffff0000, v25
    v_cvt_pk_bf16_f32 v25, v20, v21
    v_lshlrev_b32 v20, 16, v25
    v_and_b32 v21, 0xffff0000, v25
    v_cvt_pk_bf16_f32 v25, v22, v23
    v_lshlrev_b32 v22, 16, v25
    v_and_b32 v23, 0xffff0000, v25
    v_add_f32 v12, v12, v40
    v_add_f32 v13, v13, v41
    v_add_f32 v14, v14, v42
    v_add_f32 v15, v15, v43
    v_add_f32 v16, v16, v44
    v_add_f32 v17, v17, v45
    v_add_f32 v18, v18, v46
    v_add_f32 v19, v19, v47
    v_add_f32 v20, v20, v48
    v_add_f32 v21, v21, v49
    v_add_f32 v22, v22, v50
    v_add_f32 v23, v23, v51
    v_cvt_pk_bf16_f32 v4, v12, v13
    v_cvt_pk_bf16_f32 v5, v14, v15
    v_cvt_pk_bf16_f32 v6, v16, v17
    v_cvt_pk_bf16_f32 v7, v18, v19
    v_cvt_pk_bf16_f32 v8, v20, v21
    v_cvt_pk_bf16_f32 v9, v22, v23
    buffer_store_dwordx2 v[4:5], v3, s[20:23], s26 offen
    buffer_store_dwordx2 v[6:7], v3, s[20:23], s26 offen offset:512
    buffer_store_dwordx2 v[8:9], v3, s[20:23], s26 offen offset:1024
    s_waitcnt vmcnt(0)
L_dit_ln1_kernel_1:
    s_endpgm
.section .rodata,"a"
.p2align 6
.amdhsa_kernel dit_ln1_kernel
  .amdhsa_next_free_vgpr 72
  .amdhsa_next_free_sgpr 100
  .amdhsa_accum_offset 72
  .amdhsa_group_segment_fixed_size 0
  .amdhsa_kernarg_size 80
  .amdhsa_user_sgpr_count 2
  .amdhsa_user_sgpr_kernarg_segment_ptr 1
  .amdhsa_system_sgpr_workgroup_id_x 1
.end_amdhsa_kernel
.text
.globl dit_qkv_kernel
.p2align 8
.type dit_qkv_kernel,@function
dit_qkv_kernel:
    s_cmp_ge_u32 s2, 192
    s_cbranch_scc1 L_dit_qkv_kernel_1
    s_load_dwordx2 s[4:5], s[0:1], 72
    s_load_dwordx2 s[6:7], s[0:1], 16
    s_load_dwordx2 s[8:9], s[0:1], 72
    s_load_dwordx2 s[10:11], s[0:1], 72
    s_and_b32 s54, s2, 7
    s_mul_i32 s54, s54, 24
    s_lshr_b32 s55, s2, 3
    s_add_u32 s54, s54, s55
    s_mul_hi_u32 s30, s54, 357913942
    s_mul_i32 s31, s30, 12
    s_sub_u32 s31, s54, s31
    s_mul_hi_u32 s32, s30, 268435457
    s_mul_i32 s33, s32, 16
    s_sub_u32 s33, s30, s33
    v_lshrrev_b32 v1, 6, v0
    v_and_b32 v2, 63, v0
    s_nop 0
    v_readfirstlane_b32 s3, v1
    v_and_b32 v1, 3, v1
    s_lshr_b32 s53, s3, 2
    s_and_b32 s3, s3, 3
    s_waitcnt lgkmcnt(0)
    s_mul_i32 s34, s32, 0
    s_add_u32 s34, s34, 1048576
    s_add_u32 s12, s4, s34
    s_addc_u32 s13, s5, 0
    s_mov_b32 s14, 3145728
    s_mov_b32 s15, 0x00020000
    s_mul_i32 s34, s32, 0
    s_add_u32 s34, s34, 0
    s_add_u32 s16, s6, s34
    s_addc_u32 s17, s7, 0
    s_mov_b32 s18, 3538944
    s_mov_b32 s19, 0x00020000
    s_mul_i32 s34, s32, 0
    s_add_u32 s34, s34, 4194304
    s_add_u32 s20, s8, s34
    s_addc_u32 s21, s9, 0
    s_mov_b32 s22, 9437184
    s_mov_b32 s23, 0x00020000
    s_mov_b32 s24, s10
    s_mov_b32 s25, s11
    s_mov_b32 s26, 36864
    s_mov_b32 s27, 0x00020000
    v_lshrrev_b32 v27, 3, v2
    v_and_b32 v28, 7, v2
    v_xor_b32 v28, v28, v27
    s_mul_i32 s35, s33, 128
    s_lshl_b32 s36, s3, 3
    s_add_u32 s35, s35, s36
    v_add_u32 v29, s35, v27
    s_mov_b32 s36, 1536
    v_mul_lo_u32 v29, v29, s36
    v_lshl_add_u32 v4, v28, 4, v29
    s_mov_b32 s36, 178956971
    s_mul_i32 s35, s31, 384
    s_mov_b32 s37, 4608
    s_lshl_b32 s43, s3, 6
    v_add_u32 v29, s43, v2
    v_add_u32 v29, 0, v29
    v_mul_hi_u32 v30, v29, s36
    v_mul_u32_u24 v31, 24, v30
    v_sub_u32 v31, v29, v31
    v_bfe_u32 v33, v30, 3, 1
    v_bfe_u32 v32, v30, 1, 1
    v_lshl_or_b32 v32, v33, 1, v32
    v_lshrrev_b32 v33, 1, v31
    v_xor_b32 v33, v33, v32
    v_and_b32 v31, 1, v31
    v_lshl_or_b32 v31, v33, 1, v31
    v_mul_lo_u32 v32, v30, s37
    v_lshl_add_u32 v32, v31, 4, v32
    v_add_u32 v5, s35, v32
    s_lshl_b32 s43, s3, 6
    v_add_u32 v29, s43, v2
    v_add_u32 v29, 256, v29
    v_mul_hi_u32 v30, v29, s36
    v_mul_u32_u24 v31, 24, v30
    v_sub_u32 v31, v29, v31
    v_bfe_u32 v33, v30, 3, 1
    v_bfe_u32 v32, v30, 1, 1
    v_lshl_or_b32 v32, v33, 1, v32
    v_lshrrev_b32 v33, 1, v31
    v_xor_b32 v33, v33, v32
    v_and_b32 v31, 1, v31
    v_lshl_or_b32 v31, v33, 1, v31
    v_mul_lo_u32 v32, v30, s37
    v_lshl_add_u32 v32, v31, 4, v32
    v_add_u32 v6, s35, v32
    s_lshl_b32 s43, s3, 6
    v_add_u32 v29, s43, v2
    v_add_u32 v29, 512, v29
    v_mul_hi_u32 v30, v29, s36
    v_mul_u32_u24 v31, 24, v30
    v_sub_u32 v31, v29, v31
    v_bfe_u32 v33, v30, 3, 1
    v_bfe_u32 v32, v30, 1, 1
    v_lshl_or_b32 v32, v33, 1, v32
    v_lshrrev_b32 v33, 1, v31
    v_xor_b32 v33, v33, v32
    v_and_b32 v31, 1, v31
    v_lshl_or_b32 v31, v33, 1, v31
    v_mul_lo_u32 v32, v30, s37
    v_lshl_add_u32 v32, v31, 4, v32
    v_add_u32 v7, s35, v32
    s_lshl_b32 s43, s3, 6
    v_add_u32 v29, s43, v2
    v_add_u32 v29, 768, v29
    v_mul_hi_u32 v30, v29, s36
    v_mul_u32_u24 v31, 24, v30
    v_sub_u32 v31, v29, v31
    v_bfe_u32 v33, v30, 3, 1
    v_bfe_u32 v32, v30, 1, 1
    v_lshl_or_b32 v32, v33, 1, v32
    v_lshrrev_b32 v33, 1, v31
    v_xor_b32 v33, v33, v32
    v_and_b32 v31, 1, v31
    v_lshl_or_b32 v31, v33, 1, v31
    v_mul_lo_u32 v32, v30, s37
    v_lshl_add_u32 v32, v31, 4, v32
    v_add_u32 v8, s35, v32
    s_lshl_b32 s43, s3, 6
    v_add_u32 v29, s43, v2
    v_add_u32 v29, 1024, v29
    v_mul_hi_u32 v30, v29, s36
    v_mul_u32_u24 v31, 24, v30
    v_sub_u32 v31, v29, v31
    v_bfe_u32 v33, v30, 3, 1
    v_bfe_u32 v32, v30, 1, 1
    v_lshl_or_b32 v32, v33, 1, v32
    v_lshrrev_b32 v33, 1, v31
    v_xor_b32 v33, v33, v32
    v_and_b32 v31, 1, v31
    v_lshl_or_b32 v31, v33, 1, v31
    v_mul_lo_u32 v32, v30, s37
    v_lshl_add_u32 v32, v31, 4, v32
    v_add_u32 v9, s35, v32
    s_lshl_b32 s43, s3, 6
    v_add_u32 v29, s43, v2
    v_add_u32 v29, 1280, v29
    v_mul_hi_u32 v30, v29, s36
    v_mul_u32_u24 v31, 24, v30
    v_sub_u32 v31, v29, v31
    v_bfe_u32 v33, v30, 3, 1
    v_bfe_u32 v32, v30, 1, 1
    v_lshl_or_b32 v32, v33, 1, v32
    v_lshrrev_b32 v33, 1, v31
    v_xor_b32 v33, v33, v32
    v_and_b32 v31, 1, v31
    v_lshl_or_b32 v31, v33, 1, v31
    v_mul_lo_u32 v32, v30, s37
    v_lshl_add_u32 v32, v31, 4, v32
    v_add_u32 v10, s35, v32
    v_lshrrev_b32 v27, 1, v1
    v_and_b32 v28, 1, v1
    v_and_b32 v29, 15, v2
    v_lshrrev_b32 v30, 4, v2
    v_mul_u32_u24 v31, 64, v27
    v_add_u32 v31, v31, v29
    v_and_b32 v32, 7, v2
    v_xor_b32 v32, v32, v30
    v_lshlrev_b32 v32, 4, v32
    v_lshl_add_u32 v11, v31, 7, v32
    v_xor_b32 v12, 64, v11
    v_lshrrev_b32 v31, 2, v29
    v_lshl_add_u32 v31, v30, 3, v31
    v_bfe_u32 v33, v31, 3, 1
    v_bfe_u32 v32, v31, 1, 1
    v_lshl_or_b32 v32, v33, 1, v32
    v_mul_u32_u24 v31, 384, v31
    v_and_b32 v33, 3, v2
    v_lshl_add_u32 v31, v33, 3, v31
    v_add_u32 v31, 16384, v31
    v_mul_u32_u24 v33, 6, v28
    v_add_u32 v33, 0, v33
    v_xor_b32 v33, v33, v32
    v_lshl_add_u32 v13, v33, 5, v31
    v_mul_u32_u24 v33, 6, v28
    v_add_u32 v33, 1, v33
    v_xor_b32 v33, v33, v32
    v_lshl_add_u32 v14, v33, 5, v31
    v_mul_u32_u24 v33, 6, v28
    v_add_u32 v33, 2, v33
    v_xor_b32 v33, v33, v32
    v_lshl_add_u32 v15, v33, 5, v31
    v_mul_u32_u24 v33, 6, v28
    v_add_u32 v33, 3, v33
    v_xor_b32 v33, v33, v32
    v_lshl_add_u32 v16, v33, 5, v31
    v_mul_u32_u24 v33, 6, v28
    v_add_u32 v33, 4, v33
    v_xor_b32 v33, v33, v32
    v_lshl_add_u32 v17, v33, 5, v31
    v_mul_u32_u24 v33, 6, v28
    v_add_u32 v33, 5, v33
    v_xor_b32 v33, v33, v32
    v_lshl_add_u32 v18, v33, 5, v31
    v_mov_b32 v152, 0
    v_mov_b32 v153, 0
    v_mov_b32 v154, 0
    v_mov_b32 v155, 0
    v_mov_b32 v156, 0
    v_mov_b32 v157, 0
    v_mov_b32 v158, 0
    v_mov_b32 v159, 0
    v_mov_b32 v160, 0
    v_mov_b32 v161, 0
    v_mov_b32 v162, 0
    v_mov_b32 v163, 0
    v_mov_b32 v164, 0
    v_mov_b32 v165, 0
    v_mov_b32 v166, 0
    v_mov_b32 v167, 0
    v_mov_b32 v168, 0
    v_mov_b32 v169, 0
    v_mov_b32 v170, 0
    v_mov_b32 v171, 0
    v_mov_b32 v172, 0
    v_mov_b32 v173, 0
    v_mov_b32 v174, 0
    v_mov_b32 v175, 0
    v_mov_b32 v176, 0
    v_mov_b32 v177, 0
    v_mov_b32 v178, 0
    v_mov_b32 v179, 0
    v_mov_b32 v180, 0
    v_mov_b32 v181, 0
    v_mov_b32 v182, 0
    v_mov_b32 v183, 0
    v_mov_b32 v184, 0
    v_mov_b32 v185, 0
    v_mov_b32 v186, 0
    v_mov_b32 v187, 0
    v_mov_b32 v188, 0
    v_mov_b32 v189, 0
    v_mov_b32 v190, 0
    v_mov_b32 v191, 0
    v_mov_b32 v192, 0
    v_mov_b32 v193, 0
    v_mov_b32 v194, 0
    v_mov_b32 v195, 0
    v_mov_b32 v196, 0
    v_mov_b32 v197, 0
    v_mov_b32 v198, 0
    v_mov_b32 v199, 0
    v_mov_b32 v200, 0
    v_mov_b32 v201, 0
    v_mov_b32 v202, 0
    v_mov_b32 v203, 0
    v_mov_b32 v204, 0
    v_mov_b32 v205, 0
    v_mov_b32 v206, 0
    v_mov_b32 v207, 0
    v_mov_b32 v208, 0
    v_mov_b32 v209, 0
    v_mov_b32 v210, 0
    v_mov_b32 v211, 0
    v_mov_b32 v212, 0
    v_mov_b32 v213, 0
    v_mov_b32 v214, 0
    v_mov_b32 v215, 0
    v_mov_b32 v216, 0
    v_mov_b32 v217, 0
    v_mov_b32 v218, 0
    v_mov_b32 v219, 0
    v_mov_b32 v220, 0
    v_mov_b32 v221, 0
    v_mov_b32 v222, 0
    v_mov_b32 v223, 0
    v_mov_b32 v224, 0
    v_mov_b32 v225, 0
    v_mov_b32 v226, 0
    v_mov_b32 v227, 0
    v_mov_b32 v228, 0
    v_mov_b32 v229, 0
    v_mov_b32 v230, 0
    v_mov_b32 v231, 0
    v_mov_b32 v232, 0
    v_mov_b32 v233, 0
    v_mov_b32 v234, 0
    v_mov_b32 v235, 0
    v_mov_b32 v236, 0
    v_mov_b32 v237, 0
    v_mov_b32 v238, 0
    v_mov_b32 v239, 0
    v_mov_b32 v240, 0
    v_mov_b32 v241, 0
    v_mov_b32 v242, 0
    v_mov_b32 v243, 0
    v_mov_b32 v244, 0
    v_mov_b32 v245, 0
    v_mov_b32 v246, 0
    v_mov_b32 v247, 0
    s_mov_b32 s38, 0
    s_mov_b32 s39, 0
    s_lshl_b32 s48, s3, 10
    s_mov_b32 s49, s48
    s_mov_b32 s50, 0
    s_mov_b32 s42, 9
    s_cmp_eq_u32 s53, 0
    s_cbranch_scc1 L_dit_qkv_kernel_2
    s_add_u32 m0, s49, 0
    s_add_u32 s51, s38, 0
    buffer_load_dwordx4 v4, s[12:15], s51 offen lds
    s_add_u32 m0, s49, 4096
    s_add_u32 s51, s38, 49152
    buffer_load_dwordx4 v4, s[12:15], s51 offen lds
    s_add_u32 m0, s49, 8192
    s_add_u32 s51, s38, 98304
    buffer_load_dwordx4 v4, s[12:15], s51 offen lds
    s_add_u32 m0, s49, 12288
    s_add_u32 s51, s38, 147456
    buffer_load_dwordx4 v4, s[12:15], s51 offen lds
    s_add_u32 m0, s49, 16384
    s_nop 0
    buffer_load_dwordx4 v5, s[16:19], s39 offen lds
    s_add_u32 m0, s49, 20480
    s_nop 0
    buffer_load_dwordx4 v6, s[16:19], s39 offen lds
    s_add_u32 m0, s49, 24576
    s_nop 0
    buffer_load_dwordx4 v7, s[16:19], s39 offen lds
    s_add_u32 m0, s49, 28672
    s_nop 0
    buffer_load_dwordx4 v8, s[16:19], s39 offen lds
    s_add_u32 m0, s49, 32768
    s_nop 0
    buffer_load_dwordx4 v9, s[16:19], s39 offen lds
    s_add_u32 m0, s49, 36864
    s_nop 0
    buffer_load_dwordx4 v10, s[16:19], s39 offen lds
    s_add_u32 s38, s38, 128
    s_add_u32 s39, s39, 294912
    s_add_u32 s49, s49, 40960
    s_sub_u32 s51, s49, s48
    s_cmp_ge_u32 s51, 163840
    s_cselect_b32 s49, s48, s49
    s_add_u32 m0, s49, 0
    s_add_u32 s51, s38, 0
    buffer_load_dwordx4 v4, s[12:15], s51 offen lds
    s_add_u32 m0, s49, 4096
    s_add_u32 s51, s38, 49152
    buffer_load_dwordx4 v4, s[12:15], s51 offen lds
    s_add_u32 m0, s49, 8192
    s_add_u32 s51, s38, 98304
    buffer_load_dwordx4 v4, s[12:15], s51 offen lds
    s_add_u32 m0, s49, 12288
    s_add_u32 s51, s38, 147456
    buffer_load_dwordx4 v4, s[12:15], s51 offen lds
    s_add_u32 m0, s49, 16384
    s_nop 0
    buffer_load_dwordx4 v5, s[16:19], s39 offen lds
    s_add_u32 m0, s49, 20480
    s_nop 0
    buffer_load_dwordx4 v6, s[16:19], s39 offen lds
    s_add_u32 m0, s49, 24576
    s_nop 0
    buffer_load_dwordx4 v7, s[16:19], s39 offen lds
    s_add_u32 m0, s49, 28672
    s_nop 0
    buffer_load_dwordx4 v8, s[16:19], s39 offen lds
    s_add_u32 m0, s49, 32768
    s_nop 0
    buffer_load_dwordx4 v9, s[16:19], s39 offen lds
    s_add_u32 m0, s49, 36864
    s_nop 0
    buffer_load_dwordx4 v10, s[16:19], s39 offen lds
    s_add_u32 s38, s38, 128
    s_add_u32 s39, s39, 294912
    s_add_u32 s49, s49, 40960
    s_sub_u32 s51, s49, s48
    s_cmp_ge_u32 s51, 163840
    s_cselect_b32 s49, s48, s49
    s_add_u32 m0, s49, 0
    s_add_u32 s51, s38, 0
    buffer_load_dwordx4 v4, s[12:15], s51 offen lds
    s_add_u32 m0, s49, 4096
    s_add_u32 s51, s38, 49152
    buffer_load_dwordx4 v4, s[12:15], s51 offen lds
    s_add_u32 m0, s49, 8192
    s_add_u32 s51, s38, 98304
    buffer_load_dwordx4 v4, s[12:15], s51 offen lds
    s_add_u32 m0, s49, 12288
    s_add_u32 s51, s38, 147456
    buffer_load_dwordx4 v4, s[12:15], s51 offen lds
    s_add_u32 m0, s49, 16384
    s_nop 0
    buffer_load_dwordx4 v5, s[16:19], s39 offen lds
    s_add_u32 m0, s49, 20480
    s_nop 0
    buffer_load_dwordx4 v6, s[16:19], s39 offen lds
    s_add_u32 m0, s49, 24576
    s_nop 0
    buffer_load_dwordx4 v7, s[16:19], s39 offen lds
    s_add_u32 m0, s49, 28672
    s_nop 0
    buffer_load_dwordx4 v8, s[16:19], s39 offen lds
    s_add_u32 m0, s49, 32768
    s_nop 0
    buffer_load_dwordx4 v9, s[16:19], s39 offen lds
    s_add_u32 m0, s49, 36864
    s_nop 0
    buffer_load_dwordx4 v10, s[16:19], s39 offen lds
    s_add_u32 s38, s38, 128
    s_add_u32 s39, s39, 294912
    s_add_u32 s49, s49, 40960
    s_sub_u32 s51, s49, s48
    s_cmp_ge_u32 s51, 163840
    s_cselect_b32 s49, s48, s49
L_dit_qkv_kernel_3:
    s_waitcnt vmcnt(20)
    s_barrier
    s_add_u32 m0, s49, 0
    s_add_u32 s51, s38, 0
    buffer_load_dwordx4 v4, s[12:15], s51 offen lds
    s_add_u32 m0, s49, 4096
    s_add_u32 s51, s38, 49152
    buffer_load_dwordx4 v4, s[12:15], s51 offen lds
    s_add_u32 m0, s49, 8192
    s_add_u32 s51, s38, 98304
    buffer_load_dwordx4 v4, s[12:15], s51 offen lds
    s_add_u32 m0, s49, 12288
    s_add_u32 s51, s38, 147456
    buffer_load_dwordx4 v4, s[12:15], s51 offen lds
    s_add_u32 m0, s49, 16384
    s_nop 0
    buffer_load_dwordx4 v5, s[16:19], s39 offen lds
    s_add_u32 m0, s49, 20480
    s_nop 0
    buffer_load_dwordx4 v6, s[16:19], s39 offen lds
    s_add_u32 m0, s49, 24576
    s_nop 0
    buffer_load_dwordx4 v7, s[16:19], s39 offen lds
    s_add_u32 m0, s49, 28672
    s_nop 0
    buffer_load_dwordx4 v8, s[16:19], s39 offen lds
    s_add_u32 m0, s49, 32768
    s_nop 0
    buffer_load_dwordx4 v9, s[16:19], s39 offen lds
    s_add_u32 m0, s49, 36864
    s_nop 0
    buffer_load_dwordx4 v10, s[16:19], s39 offen lds
    s_add_u32 s38, s38, 128
    s_add_u32 s39, s39, 294912
    s_add_u32 s49, s49, 40960
    s_sub_u32 s51, s49, s48
    s_cmp_ge_u32 s51, 163840
    s_cselect_b32 s49, s48, s49
    s_sub_u32 s42, s42, 1
    s_cmp_lg_u32 s42, 0
    s_cbranch_scc1 L_dit_qkv_kernel_3
    s_waitcnt vmcnt(20)
    s_barrier
    s_waitcnt vmcnt(10)
    s_barrier
    s_waitcnt vmcnt(0)
    s_barrier
    s_barrier
    s_branch L_dit_qkv_kernel_1
L_dit_qkv_kernel_2:
    s_mov_b32 s42, 12
L_dit_qkv_kernel_4:
    s_barrier
    v_add_u32 v19, s50, v11
    v_add_u32 v20, s50, v12
    v_add_u32 v21, s50, v13
    v_add_u32 v22, s50, v14
    v_add_u32 v23, s50, v15
    v_add_u32 v24, s50, v16
    v_add_u32 v25, s50, v17
    v_add_u32 v26, s50, v18
    ds_read_b128 v[72:75], v19 offset:0
    ds_read_b128 v[76:79], v19 offset:2048
    ds_read_b128 v[80:83], v19 offset:4096
    ds_read_b128 v[84:87], v19 offset:6144
    ds_read_b64_tr_b16 v[104:105], v21 offset:0
    ds_read_b64_tr_b16 v[106:107], v21 offset:1536
    ds_read_b64_tr_b16 v[108:109], v22 offset:0
    ds_read_b64_tr_b16 v[110:111], v22 offset:1536
    ds_read_b64_tr_b16 v[112:113], v23 offset:0
    ds_read_b64_tr_b16 v[114:115], v23 offset:1536
    ds_read_b64_tr_b16 v[116:117], v24 offset:0
    ds_read_b64_tr_b16 v[118:119], v24 offset:1536
    ds_read_b64_tr_b16 v[120:121], v25 offset:0
    ds_read_b64_tr_b16 v[122:123], v25 offset:1536
    ds_read_b64_tr_b16 v[124:125], v26 offset:0
    ds_read_b64_tr_b16 v[126:127], v26 offset:1536
    ds_read_b128 v[88:91], v20 offset:0
    ds_read_b128 v[92:95], v20 offset:2048
    ds_read_b128 v[96:99], v20 offset:4096
    ds_read_b128 v[100:103], v20 offset:6144
    ds_read_b64_tr_b16 v[128:129], v21 offset:12288
    ds_read_b64_tr_b16 v[130:131], v21 offset:13824
    ds_read_b64_tr_b16 v[132:133], v22 offset:12288
    ds_read_b64_tr_b16 v[134:135], v22 offset:13824
    ds_read_b64_tr_b16 v[136:137], v23 offset:12288
    ds_read_b64_tr_b16 v[138:139], v23 offset:13824
    ds_read_b64_tr_b16 v[140:141], v24 offset:12288
    ds_read_b64_tr_b16 v[142:143], v24 offset:13824
    ds_read_b64_tr_b16 v[144:145], v25 offset:12288
    ds_read_b64_tr_b16 v[146:147], v25 offset:13824
    ds_read_b64_tr_b16 v[148:149], v26 offset:12288
    ds_read_b64_tr_b16 v[150:151], v26 offset:13824
    s_waitcnt lgkmcnt(15)
    v_mfma_f32_16x16x32_bf16 v[152:155], v[104:107], v[72:75], v[152:155]
    v_mfma_f32_16x16x32_bf16 v[156:159], v[108:111], v[72:75], v[156:159]
    v_mfma_f32_16x16x32_bf16 v[160:163], v[112:115], v[72:75], v[160:163]
    v_mfma_f32_16x16x32_bf16 v[164:167], v[116:119], v[72:75], v[164:167]
    v_mfma_f32_16x16x32_bf16 v[168:171], v[120:123], v[72:75], v[168:171]
    v_mfma_f32_16x16x32_bf16 v[172:175], v[124:127], v[72:75], v[172:175]
    v_mfma_f32_16x16x32_bf16 v[176:179], v[104:107], v[76:79], v[176:179]
    v_mfma_f32_16x16x32_bf16 v[180:183], v[108:111], v[76:79], v[180:183]
    v_mfma_f32_16x16x32_bf16 v[184:187], v[112:115], v[76:79], v[184:187]
    v_mfma_f32_16x16x32_bf16 v[188:191], v[116:119], v[76:79], v[188:191]
    v_mfma_f32_16x16x32_bf16 v[192:195], v[120:123], v[76:79], v[192:195]
    v_mfma_f32_16x16x32_bf16 v[196:199], v[124:127], v[76:79], v[196:199]
    v_mfma_f32_16x16x32_bf16 v[200:203], v[104:107], v[80:83], v[200:203]
    v_mfma_f32_16x16x32_bf16 v[204:207], v[108:111], v[80:83], v[204:207]
    v_mfma_f32_16x16x32_bf16 v[208:211], v[112:115], v[80:83], v[208:211]
    v_mfma_f32_16x16x32_bf16 v[212:215], v[116:119], v[80:83], v[212:215]
    v_mfma_f32_16x16x32_bf16 v[216:219], v[120:123], v[80:83], v[216:219]
    v_mfma_f32_16x16x32_bf16 v[220:223], v[124:127], v[80:83], v[220:223]
    v_mfma_f32_16x16x32_bf16 v[224:227], v[104:107], v[84:87], v[224:227]
    v_mfma_f32_16x16x32_bf16 v[228:231], v[108:111], v[84:87], v[228:231]
    v_mfma_f32_16x16x32_bf16 v[232:235], v[112:115], v[84:87], v[232:235]
    v_mfma_f32_16x16x32_bf16 v[236:239], v[116:119], v[84:87], v[236:239]
    v_mfma_f32_16x16x32_bf16 v[240:243], v[120:123], v[84:87], v[240:243]
    v_mfma_f32_16x16x32_bf16 v[244:247], v[124:127], v[84:87], v[244:247]
    s_waitcnt lgkmcnt(0)
    v_mfma_f32_16x16x32_bf16 v[152:155], v[128:131], v[88:91], v[152:155]
    v_mfma_f32_16x16x32_bf16 v[156:159], v[132:135], v[88:91], v[156:159]
    v_mfma_f32_16x16x32_bf16 v[160:163], v[136:139], v[88:91], v[160:163]
    v_mfma_f32_16x16x32_bf16 v[164:167], v[140:143], v[88:91], v[164:167]
    v_mfma_f32_16x16x32_bf16 v[168:171], v[144:147], v[88:91], v[168:171]
    v_mfma_f32_16x16x32_bf16 v[172:175], v[148:151], v[88:91], v[172:175]
    v_mfma_f32_16x16x32_bf16 v[176:179], v[128:131], v[92:95], v[176:179]
    v_mfma_f32_16x16x32_bf16 v[180:183], v[132:135], v[92:95], v[180:183]
    v_mfma_f32_16x16x32_bf16 v[184:187], v[136:139], v[92:95], v[184:187]
    v_mfma_f32_16x16x32_bf16 v[188:191], v[140:143], v[92:95], v[188:191]
    v_mfma_f32_16x16x32_bf16 v[192:195], v[144:147], v[92:95], v[192:195]
    v_mfma_f32_16x16x32_bf16 v[196:199], v[148:151], v[92:95], v[196:199]
    v_mfma_f32_16x16x32_bf16 v[200:203], v[128:131], v[96:99], v[200:203]
    v_mfma_f32_16x16x32_bf16 v[204:207], v[132:135], v[96:99], v[204:207]
    v_mfma_f32_16x16x32_bf16 v[208:211], v[136:139], v[96:99], v[208:211]
    v_mfma_f32_16x16x32_bf16 v[212:215], v[140:143], v[96:99], v[212:215]
    v_mfma_f32_16x16x32_bf16 v[216:219], v[144:147], v[96:99], v[216:219]
    v_mfma_f32_16x16x32_bf16 v[220:223], v[148:151], v[96:99], v[220:223]
    v_mfma_f32_16x16x32_bf16 v[224:227], v[128:131], v[100:103], v[224:227]
    v_mfma_f32_16x16x32_bf16 v[228:231], v[132:135], v[100:103], v[228:231]
    v_mfma_f32_16x16x32_bf16 v[232:235], v[136:139], v[100:103], v[232:235]
    v_mfma_f32_16x16x32_bf16 v[236:239], v[140:143], v[100:103], v[236:239]
    v_mfma_f32_16x16x32_bf16 v[240:243], v[144:147], v[100:103], v[240:243]
    v_mfma_f32_16x16x32_bf16 v[244:247], v[148:151], v[100:103], v[244:247]
    s_add_u32 s50, s50, 40960
    s_cmp_ge_u32 s50, 163840
    s_cselect_b32 s50, 0, s50
    s_sub_u32 s42, s42, 1
    s_cmp_lg_u32 s42, 0
    s_cbranch_scc1 L_dit_qkv_kernel_4
    s_mul_i32 s35, s33, 128
    v_mul_u32_u24 v32, 64, v27
    v_add3_u32 v32, v32, v29, s35
    s_mul_i32 s36, s31, 192
    v_mul_u32_u24 v33, 96, v28
    v_lshl_add_u32 v33, v30, 2, v33
    v_add_u32 v33, s36, v33
    s_mov_b32 s37, 4608
    v_mul_lo_u32 v31, v32, s37
    v_lshl_add_u32 v31, v33, 1, v31
    s_barrier
    s_mul_i32 s52, s3, 13312
    v_mul_u32_u24 v71, 208, v29
    v_lshl_add_u32 v71, v30, 3, v71
    v_add_u32 v71, s52, v71
    s_nop 7
    s_nop 7
    v_cvt_pk_bf16_f32 v152, v152, v153
    v_cvt_pk_bf16_f32 v153, v154, v155
    ds_write_b64 v71, v[152:153] offset:0
    v_cvt_pk_bf16_f32 v156, v156, v157
    v_cvt_pk_bf16_f32 v157, v158, v159
    ds_write_b64 v71, v[156:157] offset:32
    v_cvt_pk_bf16_f32 v160, v160, v161
    v_cvt_pk_bf16_f32 v161, v162, v163
    ds_write_b64 v71, v[160:161] offset:64
    v_cvt_pk_bf16_f32 v164, v164, v165
    v_cvt_pk_bf16_f32 v165, v166, v167
    ds_write_b64 v71, v[164:165] offset:96
    v_cvt_pk_bf16_f32 v168, v168, v169
    v_cvt_pk_bf16_f32 v169, v170, v171
    ds_write_b64 v71, v[168:169] offset:128
    v_cvt_pk_bf16_f32 v172, v172, v173
    v_cvt_pk_bf16_f32 v173, v174, v175
    ds_write_b64 v71, v[172:173] offset:160
    v_cvt_pk_bf16_f32 v176, v176, v177
    v_cvt_pk_bf16_f32 v177, v178, v179
    ds_write_b64 v71, v[176:177] offset:3328
    v_cvt_pk_bf16_f32 v180, v180, v181
    v_cvt_pk_bf16_f32 v181, v182, v183
    ds_write_b64 v71, v[180:181] offset:3360
    v_cvt_pk_bf16_f32 v184, v184, v185
    v_cvt_pk_bf16_f32 v185, v186, v187
    ds_write_b64 v71, v[184:185] offset:3392
    v_cvt_pk_bf16_f32 v188, v188, v189
    v_cvt_pk_bf16_f32 v189, v190, v191
    ds_write_b64 v71, v[188:189] offset:3424
    v_cvt_pk_bf16_f32 v192, v192, v193
    v_cvt_pk_bf16_f32 v193, v194, v195
    ds_write_b64 v71, v[192:193] offset:3456
    v_cvt_pk_bf16_f32 v196, v196, v197
    v_cvt_pk_bf16_f32 v197, v198, v199
    ds_write_b64 v71, v[196:197] offset:3488
    v_cvt_pk_bf16_f32 v200, v200, v201
    v_cvt_pk_bf16_f32 v201, v202, v203
    ds_write_b64 v71, v[200:201] offset:6656
    v_cvt_pk_bf16_f32 v204, v204, v205
    v_cvt_pk_bf16_f32 v205, v206, v207
    ds_write_b64 v71, v[204:205] offset:6688
    v_cvt_pk_bf16_f32 v208, v208, v209
    v_cvt_pk_bf16_f32 v209, v210, v211
    ds_write_b64 v71, v[208:209] offset:6720
    v_cvt_pk_bf16_f32 v212, v212, v213
    v_cvt_pk_bf16_f32 v213, v214, v215
    ds_write_b64 v71, v[212:213] offset:6752
    v_cvt_pk_bf16_f32 v216, v216, v217
    v_cvt_pk_bf16_f32 v217, v218, v219
    ds_write_b64 v71, v[216:217] offset:6784
    v_cvt_pk_bf16_f32 v220, v220, v221
    v_cvt_pk_bf16_f32 v221, v222, v223
    ds_write_b64 v71, v[220:221] offset:6816
    v_cvt_pk_bf16_f32 v224, v224, v225
    v_cvt_pk_bf16_f32 v225, v226, v227
    ds_write_b64 v71, v[224:225] offset:9984
    v_cvt_pk_bf16_f32 v228, v228, v229
    v_cvt_pk_bf16_f32 v229, v230, v231
    ds_write_b64 v71, v[228:229] offset:10016
    v_cvt_pk_bf16_f32 v232, v232, v233
    v_cvt_pk_bf16_f32 v233, v234, v235
    ds_write_b64 v71, v[232:233] offset:10048
    v_cvt_pk_bf16_f32 v236, v236, v237
    v_cvt_pk_bf16_f32 v237, v238, v239
    ds_write_b64 v71, v[236:237] offset:10080
    v_cvt_pk_bf16_f32 v240, v240, v241
    v_cvt_pk_bf16_f32 v241, v242, v243
    ds_write_b64 v71, v[240:241] offset:10112
    v_cvt_pk_bf16_f32 v244, v244, v245
    v_cvt_pk_bf16_f32 v245, v246, v247
    ds_write_b64 v71, v[244:245] offset:10144
    s_waitcnt lgkmcnt(0)
    s_mov_b32 s36, 357913942
    s_mul_i32 s35, s33, 128
    s_lshr_b32 s37, s3, 1
    s_mul_i32 s37, s37, 64
    s_add_u32 s35, s35, s37
    s_mul_i32 s35, s35, 4608
    s_mul_i32 s37, s31, 384
    s_add_u32 s35, s35, s37
    s_and_b32 s37, s3, 1
    s_mul_i32 s37, s37, 192
    s_add_u32 s35, s35, s37
    s_mov_b32 s37, 4608
    v_add_u32 v27, 0, v2
    v_mul_hi_u32 v28, v27, s36
    v_mul_u32_u24 v29, 12, v28
    v_sub_u32 v29, v27, v29
    v_mul_u32_u24 v30, 208, v28
    v_lshl_add_u32 v30, v29, 4, v30
    v_add_u32 v30, s52, v30
    ds_read_b128 v[152:155], v30
    v_mul_lo_u32 v32, v28, s37
    v_lshl_add_u32 v34, v29, 4, v32
    s_waitcnt lgkmcnt(0)
    buffer_store_dwordx4 v[152:155], v34, s[20:23], s35 offen
    v_add_u32 v27, 64, v2
    v_mul_hi_u32 v28, v27, s36
    v_mul_u32_u24 v29, 12, v28
    v_sub_u32 v29, v27, v29
    v_mul_u32_u24 v30, 208, v28
    v_lshl_add_u32 v30, v29, 4, v30
    v_add_u32 v30, s52, v30
    ds_read_b128 v[156:159], v30
    v_mul_lo_u32 v32, v28, s37
    v_lshl_add_u32 v35, v29, 4, v32
    s_waitcnt lgkmcnt(0)
    buffer_store_dwordx4 v[156:159], v35, s[20:23], s35 offen
    v_add_u32 v27, 128, v2
    v_mul_hi_u32 v28, v27, s36
    v_mul_u32_u24 v29, 12, v28
    v_sub_u32 v29, v27, v29
    v_mul_u32_u24 v30, 208, v28
    v_lshl_add_u32 v30, v29, 4, v30
    v_add_u32 v30, s52, v30
    ds_read_b128 v[160:163], v30
    v_mul_lo_u32 v32, v28, s37
    v_lshl_add_u32 v36, v29, 4, v32
    s_waitcnt lgkmcnt(0)
    buffer_store_dwordx4 v[160:163], v36, s[20:23], s35 offen
    v_add_u32 v27, 192, v2
    v_mul_hi_u32 v28, v27, s36
    v_mul_u32_u24 v29, 12, v28
    v_sub_u32 v29, v27, v29
    v_mul_u32_u24 v30, 208, v28
    v_lshl_add_u32 v30, v29, 4, v30
    v_add_u32 v30, s52, v30
    ds_read_b128 v[164:167], v30
    v_mul_lo_u32 v32, v28, s37
    v_lshl_add_u32 v37, v29, 4, v32
    s_waitcnt lgkmcnt(0)
    buffer_store_dwordx4 v[164:167], v37, s[20:23], s35 offen
    v_add_u32 v27, 256, v2
    v_mul_hi_u32 v28, v27, s36
    v_mul_u32_u24 v29, 12, v28
    v_sub_u32 v29, v27, v29
    v_mul_u32_u24 v30, 208, v28
    v_lshl_add_u32 v30, v29, 4, v30
    v_add_u32 v30, s52, v30
    ds_read_b128 v[168:171], v30
    v_mul_lo_u32 v32, v28, s37
    v_lshl_add_u32 v38, v29, 4, v32
    s_waitcnt lgkmcnt(0)
    buffer_store_dwordx4 v[168:171], v38, s[20:23], s35 offen
    v_add_u32 v27, 320, v2
    v_mul_hi_u32 v28, v27, s36
    v_mul_u32_u24 v29, 12, v28
    v_sub_u32 v29, v27, v29
    v_mul_u32_u24 v30, 208, v28
    v_lshl_add_u32 v30, v29, 4, v30
    v_add_u32 v30, s52, v30
    ds_read_b128 v[172:175], v30
    v_mul_lo_u32 v32, v28, s37
    v_lshl_add_u32 v39, v29, 4, v32
    s_waitcnt lgkmcnt(0)
    buffer_store_dwordx4 v[172:175], v39, s[20:23], s35 offen
    v_add_u32 v27, 384, v2
    v_mul_hi_u32 v28, v27, s36
    v_mul_u32_u24 v29, 12, v28
    v_sub_u32 v29, v27, v29
    v_mul_u32_u24 v30, 208, v28
    v_lshl_add_u32 v30, v29, 4, v30
    v_add_u32 v30, s52, v30
    ds_read_b128 v[176:179], v30
    v_mul_lo_u32 v32, v28, s37
    v_lshl_add_u32 v40, v29, 4, v32
    s_waitcnt lgkmcnt(0)
    buffer_store_dwordx4 v[176:179], v40, s[20:23], s35 offen
    v_add_u32 v27, 448, v2
    v_mul_hi_u32 v28, v27, s36
    v_mul_u32_u24 v29, 12, v28
    v_sub_u32 v29, v27, v29
    v_mul_u32_u24 v30, 208, v28
    v_lshl_add_u32 v30, v29, 4, v30
    v_add_u32 v30, s52, v30
    ds_read_b128 v[180:183], v30
    v_mul_lo_u32 v32, v28, s37
    v_lshl_add_u32 v41, v29, 4, v32
    s_waitcnt lgkmcnt(0)
    buffer_store_dwordx4 v[180:183], v41, s[20:23], s35 offen
    v_add_u32 v27, 512, v2
    v_mul_hi_u32 v28, v27, s36
    v_mul_u32_u24 v29, 12, v28
    v_sub_u32 v29, v27, v29
    v_mul_u32_u24 v30, 208, v28
    v_lshl_add_u32 v30, v29, 4, v30
    v_add_u32 v30, s52, v30
    ds_read_b128 v[152:155], v30
    v_mul_lo_u32 v32, v28, s37
    v_lshl_add_u32 v34, v29, 4, v32
    s_waitcnt lgkmcnt(0)
    buffer_store_dwordx4 v[152:155], v34, s[20:23], s35 offen
    v_add_u32 v27, 576, v2
    v_mul_hi_u32 v28, v27, s36
    v_mul_u32_u24 v29, 12, v28
    v_sub_u32 v29, v27, v29
    v_mul_u32_u24 v30, 208, v28
    v_lshl_add_u32 v30, v29, 4, v30
    v_add_u32 v30, s52, v30
    ds_read_b128 v[156:159], v30
    v_mul_lo_u32 v32, v28, s37
    v_lshl_add_u32 v35, v29, 4, v32
    s_waitcnt lgkmcnt(0)
    buffer_store_dwordx4 v[156:159], v35, s[20:23], s35 offen
    v_add_u32 v27, 640, v2
    v_mul_hi_u32 v28, v27, s36
    v_mul_u32_u24 v29, 12, v28
    v_sub_u32 v29, v27, v29
    v_mul_u32_u24 v30, 208, v28
    v_lshl_add_u32 v30, v29, 4, v30
    v_add_u32 v30, s52, v30
    ds_read_b128 v[160:163], v30
    v_mul_lo_u32 v32, v28, s37
    v_lshl_add_u32 v36, v29, 4, v32
    s_waitcnt lgkmcnt(0)
    buffer_store_dwordx4 v[160:163], v36, s[20:23], s35 offen
    v_add_u32 v27, 704, v2
    v_mul_hi_u32 v28, v27, s36
    v_mul_u32_u24 v29, 12, v28
    v_sub_u32 v29, v27, v29
    v_mul_u32_u24 v30, 208, v28
    v_lshl_add_u32 v30, v29, 4, v30
    v_add_u32 v30, s52, v30
    ds_read_b128 v[164:167], v30
    v_mul_lo_u32 v32, v28, s37
    v_lshl_add_u32 v37, v29, 4, v32
    s_waitcnt lgkmcnt(0)
    buffer_store_dwordx4 v[164:167], v37, s[20:23], s35 offen
    s_waitcnt vmcnt(0)
L_dit_qkv_kernel_1:
    s_endpgm
.section .rodata,"a"
.p2align 6
.amdhsa_kernel dit_qkv_kernel
  .amdhsa_next_free_vgpr 248
  .amdhsa_next_free_sgpr 100
  .amdhsa_accum_offset 248
  .amdhsa_group_segment_fixed_size 0
  .amdhsa_kernarg_size 80
  .amdhsa_user_sgpr_count 2
  .amdhsa_user_sgpr_kernarg_segment_ptr 1
  .amdhsa_system_sgpr_workgroup_id_x 1
.end_amdhsa_kernel
.text
.globl dit_s_kernel
.p2align 8
.type dit_s_kernel,@function
dit_s_kernel:
    s_cmp_ge_u32 s2, 256
    s_cbranch_scc1 L_dit_s_kernel_1
    s_load_dwordx2 s[4:5], s[0:1], 72
    s_load_dwordx2 s[6:7], s[0:1], 72
    s_load_dwordx2 s[8:9], s[0:1], 72
    s_load_dwordx2 s[10:11], s[0:1], 72
    s_and_b32 s54, s2, 7
    s_mul_i32 s54, s54, 32
    s_lshr_b32 s55, s2, 3
    s_add_u32 s54, s54, s55
    s_mul_hi_u32 s30, s54, 536870913
    s_mul_i32 s31, s30, 8
    s_sub_u32 s31, s54, s31
    s_mul_hi_u32 s32, s30, 536870913
    s_mul_i32 s33, s32, 8
    s_sub_u32 s33, s30, s33
    v_lshrrev_b32 v1, 6, v0
    v_and_b32 v2, 63, v0
    s_nop 0
    v_readfirstlane_b32 s3, v1
    v_and_b32 v1, 3, v1
    s_lshr_b32 s53, s3, 2
    s_and_b32 s3, s3, 3
    s_waitcnt lgkmcnt(0)
    s_lshr_b32 s34, s32, 1
    s_mul_i32 s34, s34, 4718592
    s_and_b32 s43, s32, 1
    s_mul_i32 s43, s43, 768
    s_add_u32 s34, s34, s43
    s_add_u32 s34, s34, 4194304
    s_add_u32 s12, s4, s34
    s_addc_u32 s13, s5, 0
    s_mov_b32 s14, 9437184
    s_mov_b32 s15, 0x00020000
    s_lshr_b32 s34, s32, 1
    s_mul_i32 s34, s34, 4718592
    s_and_b32 s43, s32, 1
    s_mul_i32 s43, s43, 768
    s_add_u32 s34, s34, s43
    s_add_u32 s34, s34, 4195840
    s_add_u32 s16, s6, s34
    s_addc_u32 s17, s7, 0
    s_mov_b32 s18, 9437184
    s_mov_b32 s19, 0x00020000
    s_mul_i32 s34, s32, 2097152
    s_add_u32 s34, s34, 16777216
    s_add_u32 s20, s8, s34
    s_addc_u32 s21, s9, 0
    s_mov_b32 s22, 8388608
    s_mov_b32 s23, 0x00020000
    s_mov_b32 s24, s10
    s_mov_b32 s25, s11
    s_mov_b32 s26, 36864
    s_mov_b32 s27, 0x00020000
    v_lshrrev_b32 v27, 3, v2
    v_and_b32 v28, 7, v2
    v_xor_b32 v28, v28, v27
    s_mul_i32 s35, s33, 128
    s_lshl_b32 s36, s3, 3
    s_add_u32 s35, s35, s36
    v_add_u32 v29, s35, v27
    s_mov_b32 s36, 4608
    v_mul_lo_u32 v29, v29, s36
    v_lshl_add_u32 v4, v28, 4, v29
    s_mul_i32 s35, s31, 128
    s_lshl_b32 s36, s3, 3
    s_add_u32 s35, s35, s36
    v_add_u32 v29, s35, v27
    s_mov_b32 s36, 4608
    v_mul_lo_u32 v29, v29, s36
    v_lshl_add_u32 v5, v28, 4, v29
    v_lshrrev_b32 v27, 1, v1
    v_and_b32 v28, 1, v1
    v_and_b32 v29, 15, v2
    v_lshrrev_b32 v30, 4, v2
    v_mul_u32_u24 v31, 64, v27
    v_add_u32 v31, v31, v29
    v_and_b32 v32, 7, v2
    v_xor_b32 v32, v32, v30
    v_lshlrev_b32 v32, 4, v32
    v_lshl_add_u32 v11, v31, 7, v32
    v_xor_b32 v12, 64, v11
    v_mul_u32_u24 v31, 64, v28
    v_add_u32 v31, v31, v29
    v_lshl_add_u32 v13, v31, 7, v32
    v_add_u32 v13, 16384, v13
    v_xor_b32 v14, 64, v13
    v_mov_b32 v136, 0
    v_mov_b32 v137, 0
    v_mov_b32 v138, 0
    v_mov_b32 v139, 0
    v_mov_b32 v140, 0
    v_mov_b32 v141, 0
    v_mov_b32 v142, 0
    v_mov_b32 v143, 0
    v_mov_b32 v144, 0
    v_mov_b32 v145, 0
    v_mov_b32 v146, 0
    v_mov_b32 v147, 0
    v_mov_b32 v148, 0
    v_mov_b32 v149, 0
    v_mov_b32 v150, 0
    v_mov_b32 v151, 0
    v_mov_b32 v152, 0
    v_mov_b32 v153, 0
    v_mov_b32 v154, 0
    v_mov_b32 v155, 0
    v_mov_b32 v156, 0
    v_mov_b32 v157, 0
    v_mov_b32 v158, 0
    v_mov_b32 v159, 0
    v_mov_b32 v160, 0
    v_mov_b32 v161, 0
    v_mov_b32 v162, 0
    v_mov_b32 v163, 0
    v_mov_b32 v164, 0
    v_mov_b32 v165, 0
    v_mov_b32 v166, 0
    v_mov_b32 v167, 0
    v_mov_b32 v168, 0
    v_mov_b32 v169, 0
    v_mov_b32 v170, 0
    v_mov_b32 v171, 0
    v_mov_b32 v172, 0
    v_mov_b32 v173, 0
    v_mov_b32 v174, 0
    v_mov_b32 v175, 0
    v_mov_b32 v176, 0
    v_mov_b32 v177, 0
    v_mov_b32 v178, 0
    v_mov_b32 v179, 0
    v_mov_b32 v180, 0
    v_mov_b32 v181, 0
    v_mov_b32 v182, 0
    v_mov_b32 v183, 0
    v_mov_b32 v184, 0
    v_mov_b32 v185, 0
    v_mov_b32 v186, 0
    v_mov_b32 v187, 0
    v_mov_b32 v188, 0
    v_mov_b32 v189, 0
    v_mov_b32 v190, 0
    v_mov_b32 v191, 0
    v_mov_b32 v192, 0
    v_mov_b32 v193, 0
    v_mov_b32 v194, 0
    v_mov_b32 v195, 0
    v_mov_b32 v196, 0
    v_mov_b32 v197, 0
    v_mov_b32 v198, 0
    v_mov_b32 v199, 0
    s_mov_b32 s38, 0
    s_mov_b32 s39, 0
    s_lshl_b32 s48, s3, 10
    s_mov_b32 s49, s48
    s_mov_b32 s50, 0
    s_mov_b32 s42, 3
    s_cmp_eq_u32 s53, 0
    s_cbranch_scc1 L_dit_s_kernel_2
    s_add_u32 m0, s49, 0
    s_add_u32 s51, s38, 0
    buffer_load_dwordx4 v4, s[12:15], s51 offen lds
    s_add_u32 m0, s49, 4096
    s_add_u32 s51, s38, 147456
    buffer_load_dwordx4 v4, s[12:15], s51 offen lds
    s_add_u32 m0, s49, 8192
    s_add_u32 s51, s38, 294912
    buffer_load_dwordx4 v4, s[12:15], s51 offen lds
    s_add_u32 m0, s49, 12288
    s_add_u32 s51, s38, 442368
    buffer_load_dwordx4 v4, s[12:15], s51 offen lds
    s_add_u32 m0, s49, 16384
    s_add_u32 s51, s39, 0
    buffer_load_dwordx4 v5, s[16:19], s51 offen lds
    s_add_u32 m0, s49, 20480
    s_add_u32 s51, s39, 147456
    buffer_load_dwordx4 v5, s[16:19], s51 offen lds
    s_add_u32 m0, s49, 24576
    s_add_u32 s51, s39, 294912
    buffer_load_dwordx4 v5, s[16:19], s51 offen lds
    s_add_u32 m0, s49, 28672
    s_add_u32 s51, s39, 442368
    buffer_load_dwordx4 v5, s[16:19], s51 offen lds
    s_add_u32 s38, s38, 128
    s_add_u32 s39, s39, 128
    s_add_u32 s49, s49, 32768
    s_sub_u32 s51, s49, s48
    s_cmp_ge_u32 s51, 131072
    s_cselect_b32 s49, s48, s49
    s_add_u32 m0, s49, 0
    s_add_u32 s51, s38, 0
    buffer_load_dwordx4 v4, s[12:15], s51 offen lds
    s_add_u32 m0, s49, 4096
    s_add_u32 s51, s38, 147456
    buffer_load_dwordx4 v4, s[12:15], s51 offen lds
    s_add_u32 m0, s49, 8192
    s_add_u32 s51, s38, 294912
    buffer_load_dwordx4 v4, s[12:15], s51 offen lds
    s_add_u32 m0, s49, 12288
    s_add_u32 s51, s38, 442368
    buffer_load_dwordx4 v4, s[12:15], s51 offen lds
    s_add_u32 m0, s49, 16384
    s_add_u32 s51, s39, 0
    buffer_load_dwordx4 v5, s[16:19], s51 offen lds
    s_add_u32 m0, s49, 20480
    s_add_u32 s51, s39, 147456
    buffer_load_dwordx4 v5, s[16:19], s51 offen lds
    s_add_u32 m0, s49, 24576
    s_add_u32 s51, s39, 294912
    buffer_load_dwordx4 v5, s[16:19], s51 offen lds
    s_add_u32 m0, s49, 28672
    s_add_u32 s51, s39, 442368
    buffer_load_dwordx4 v5, s[16:19], s51 offen lds
    s_add_u32 s38, s38, 128
    s_add_u32 s39, s39, 128
    s_add_u32 s49, s49, 32768
    s_sub_u32 s51, s49, s48
    s_cmp_ge_u32 s51, 131072
    s_cselect_b32 s49, s48, s49
    s_add_u32 m0, s49, 0
    s_add_u32 s51, s38, 0
    buffer_load_dwordx4 v4, s[12:15], s51 offen lds
    s_add_u32 m0, s49, 4096
    s_add_u32 s51, s38, 147456
    buffer_load_dwordx4 v4, s[12:15], s51 offen lds
    s_add_u32 m0, s49, 8192
    s_add_u32 s51, s38, 294912
    buffer_load_dwordx4 v4, s[12:15], s51 offen lds
    s_add_u32 m0, s49, 12288
    s_add_u32 s51, s38, 442368
    buffer_load_dwordx4 v4, s[12:15], s51 offen lds
    s_add_u32 m0, s49, 16384
    s_add_u32 s51, s39, 0
    buffer_load_dwordx4 v5, s[16:19], s51 offen lds
    s_add_u32 m0, s49, 20480
    s_add_u32 s51, s39, 147456
    buffer_load_dwordx4 v5, s[16:19], s51 offen lds
    s_add_u32 m0, s49, 24576
    s_add_u32 s51, s39, 294912
    buffer_load_dwordx4 v5, s[16:19], s51 offen lds
    s_add_u32 m0, s49, 28672
    s_add_u32 s51, s39, 442368
    buffer_load_dwordx4 v5, s[16:19], s51 offen lds
    s_add_u32 s38, s38, 128
    s_add_u32 s39, s39, 128
    s_add_u32 s49, s49, 32768
    s_sub_u32 s51, s49, s48
    s_cmp_ge_u32 s51, 131072
    s_cselect_b32 s49, s48, s49
L_dit_s_kernel_3:
    s_waitcnt vmcnt(16)
    s_barrier
    s_add_u32 m0, s49, 0
    s_add_u32 s51, s38, 0
    buffer_load_dwordx4 v4, s[12:15], s51 offen lds
    s_add_u32 m0, s49, 4096
    s_add_u32 s51, s38, 147456
    buffer_load_dwordx4 v4, s[12:15], s51 offen lds
    s_add_u32 m0, s49, 8192
    s_add_u32 s51, s38, 294912
    buffer_load_dwordx4 v4, s[12:15], s51 offen lds
    s_add_u32 m0, s49, 12288
    s_add_u32 s51, s38, 442368
    buffer_load_dwordx4 v4, s[12:15], s51 offen lds
    s_add_u32 m0, s49, 16384
    s_add_u32 s51, s39, 0
    buffer_load_dwordx4 v5, s[16:19], s51 offen lds
    s_add_u32 m0, s49, 20480
    s_add_u32 s51, s39, 147456
    buffer_load_dwordx4 v5, s[16:19], s51 offen lds
    s_add_u32 m0, s49, 24576
    s_add_u32 s51, s39, 294912
    buffer_load_dwordx4 v5, s[16:19], s51 offen lds
    s_add_u32 m0, s49, 28672
    s_add_u32 s51, s39, 442368
    buffer_load_dwordx4 v5, s[16:19], s51 offen lds
    s_add_u32 s38, s38, 128
    s_add_u32 s39, s39, 128
    s_add_u32 s49, s49, 32768
    s_sub_u32 s51, s49, s48
    s_cmp_ge_u32 s51, 131072
    s_cselect_b32 s49, s48, s49
    s_sub_u32 s42, s42, 1
    s_cmp_lg_u32 s42, 0
    s_cbranch_scc1 L_dit_s_kernel_3
    s_waitcnt vmcnt(16)
    s_barrier
    s_waitcnt vmcnt(8)
    s_barrier
    s_waitcnt vmcnt(0)
    s_barrier
    s_barrier
    s_branch L_dit_s_kernel_1
L_dit_s_kernel_2:
    s_mov_b32 s42, 6
L_dit_s_kernel_4:
    s_barrier
    v_add_u32 v19, s50, v11
    v_add_u32 v20, s50, v12
    v_add_u32 v21, s50, v13
    v_add_u32 v22, s50, v14
    ds_read_b128 v[72:75], v19 offset:0
    ds_read_b128 v[76:79], v19 offset:2048
    ds_read_b128 v[80:83], v19 offset:4096
    ds_read_b128 v[84:87], v19 offset:6144
    ds_read_b128 v[104:107], v21 offset:0
    ds_read_b128 v[108:111], v21 offset:2048
    ds_read_b128 v[112:115], v21 offset:4096
    ds_read_b128 v[116:119], v21 offset:6144
    ds_read_b128 v[88:91], v20 offset:0
    ds_read_b128 v[92:95], v20 offset:2048
    ds_read_b128 v[96:99], v20 offset:4096
    ds_read_b128 v[100:103], v20 offset:6144
    ds_read_b128 v[120:123], v22 offset:0
    ds_read_b128 v[124:127], v22 offset:2048
    ds_read_b128 v[128:131], v22 offset:4096
    ds_read_b128 v[132:135], v22 offset:6144
    s_waitcnt lgkmcnt(8)
    v_mfma_f32_16x16x32_bf16 v[136:139], v[104:107], v[72:75], v[136:139]
    v_mfma_f32_16x16x32_bf16 v[140:143], v[108:111], v[72:75], v[140:143]
    v_mfma_f32_16x16x32_bf16 v[144:147], v[112:115], v[72:75], v[144:147]
    v_mfma_f32_16x16x32_bf16 v[148:151], v[116:119], v[72:75], v[148:151]
    v_mfma_f32_16x16x32_bf16 v[152:155], v[104:107], v[76:79], v[152:155]
    v_mfma_f32_16x16x32_bf16 v[156:159], v[108:111], v[76:79], v[156:159]
    v_mfma_f32_16x16x32_bf16 v[160:163], v[112:115], v[76:79], v[160:163]
    v_mfma_f32_16x16x32_bf16 v[164:167], v[116:119], v[76:79], v[164:167]
    v_mfma_f32_16x16x32_bf16 v[168:171], v[104:107], v[80:83], v[168:171]
    v_mfma_f32_16x16x32_bf16 v[172:175], v[108:111], v[80:83], v[172:175]
    v_mfma_f32_16x16x32_bf16 v[176:179], v[112:115], v[80:83], v[176:179]
    v_mfma_f32_16x16x32_bf16 v[180:183], v[116:119], v[80:83], v[180:183]
    v_mfma_f32_16x16x32_bf16 v[184:187], v[104:107], v[84:87], v[184:187]
    v_mfma_f32_16x16x32_bf16 v[188:191], v[108:111], v[84:87], v[188:191]
    v_mfma_f32_16x16x32_bf16 v[192:195], v[112:115], v[84:87], v[192:195]
    v_mfma_f32_16x16x32_bf16 v[196:199], v[116:119], v[84:87], v[196:199]
    s_waitcnt lgkmcnt(0)
    v_mfma_f32_16x16x32_bf16 v[136:139], v[120:123], v[88:91], v[136:139]
    v_mfma_f32_16x16x32_bf16 v[140:143], v[124:127], v[88:91], v[140:143]
    v_mfma_f32_16x16x32_bf16 v[144:147], v[128:131], v[88:91], v[144:147]
    v_mfma_f32_16x16x32_bf16 v[148:151], v[132:135], v[88:91], v[148:151]
    v_mfma_f32_16x16x32_bf16 v[152:155], v[120:123], v[92:95], v[152:155]
    v_mfma_f32_16x16x32_bf16 v[156:159], v[124:127], v[92:95], v[156:159]
    v_mfma_f32_16x16x32_bf16 v[160:163], v[128:131], v[92:95], v[160:163]
    v_mfma_f32_16x16x32_bf16 v[164:167], v[132:135], v[92:95], v[164:167]
    v_mfma_f32_16x16x32_bf16 v[168:171], v[120:123], v[96:99], v[168:171]
    v_mfma_f32_16x16x32_bf16 v[172:175], v[124:127], v[96:99], v[172:175]
    v_mfma_f32_16x16x32_bf16 v[176:179], v[128:131], v[96:99], v[176:179]
    v_mfma_f32_16x16x32_bf16 v[180:183], v[132:135], v[96:99], v[180:183]
    v_mfma_f32_16x16x32_bf16 v[184:187], v[120:123], v[100:103], v[184:187]
    v_mfma_f32_16x16x32_bf16 v[188:191], v[124:127], v[100:103], v[188:191]
    v_mfma_f32_16x16x32_bf16 v[192:195], v[128:131], v[100:103], v[192:195]
    v_mfma_f32_16x16x32_bf16 v[196:199], v[132:135], v[100:103], v[196:199]
    s_add_u32 s50, s50, 32768
    s_cmp_ge_u32 s50, 131072
    s_cselect_b32 s50, 0, s50
    s_sub_u32 s42, s42, 1
    s_cmp_lg_u32 s42, 0
    s_cbranch_scc1 L_dit_s_kernel_4
    s_mul_i32 s35, s33, 128
    v_mul_u32_u24 v32, 64, v27
    v_add3_u32 v32, v32, v29, s35
    s_mul_i32 s36, s31, 128
    v_mul_u32_u24 v33, 64, v28
    v_lshl_add_u32 v33, v30, 2, v33
    v_add_u32 v33, s36, v33
    s_mov_b32 s37, 2048
    v_mul_lo_u32 v31, v32, s37
    v_lshl_add_u32 v31, v33, 1, v31
    s_barrier
    s_mul_i32 s52, s3, 9216
    v_mul_u32_u24 v71, 144, v29
    v_lshl_add_u32 v71, v30, 3, v71
    v_add_u32 v71, s52, v71
    s_nop 7
    s_nop 7
    v_cvt_pk_bf16_f32 v32, v136, v137
    v_lshlrev_b32 v136, 16, v32
    v_and_b32 v137, 0xffff0000, v32
    v_cvt_pk_bf16_f32 v32, v138, v139
    v_lshlrev_b32 v138, 16, v32
    v_and_b32 v139, 0xffff0000, v32
    v_mul_f32 v136, 0x3d5105ec, v136
    v_mul_f32 v137, 0x3d5105ec, v137
    v_mul_f32 v138, 0x3d5105ec, v138
    v_mul_f32 v139, 0x3d5105ec, v139
    v_cvt_pk_bf16_f32 v136, v136, v137
    v_cvt_pk_bf16_f32 v137, v138, v139
    ds_write_b64 v71, v[136:137] offset:0
    v_cvt_pk_bf16_f32 v32, v140, v141
    v_lshlrev_b32 v140, 16, v32
    v_and_b32 v141, 0xffff0000, v32
    v_cvt_pk_bf16_f32 v32, v142, v143
    v_lshlrev_b32 v142, 16, v32
    v_and_b32 v143, 0xffff0000, v32
    v_mul_f32 v140, 0x3d5105ec, v140
    v_mul_f32 v141, 0x3d5105ec, v141
    v_mul_f32 v142, 0x3d5105ec, v142
    v_mul_f32 v143, 0x3d5105ec, v143
    v_cvt_pk_bf16_f32 v140, v140, v141
    v_cvt_pk_bf16_f32 v141, v142, v143
    ds_write_b64 v71, v[140:141] offset:32
    v_cvt_pk_bf16_f32 v32, v144, v145
    v_lshlrev_b32 v144, 16, v32
    v_and_b32 v145, 0xffff0000, v32
    v_cvt_pk_bf16_f32 v32, v146, v147
    v_lshlrev_b32 v146, 16, v32
    v_and_b32 v147, 0xffff0000, v32
    v_mul_f32 v144, 0x3d5105ec, v144
    v_mul_f32 v145, 0x3d5105ec, v145
    v_mul_f32 v146, 0x3d5105ec, v146
    v_mul_f32 v147, 0x3d5105ec, v147
    v_cvt_pk_bf16_f32 v144, v144, v145
    v_cvt_pk_bf16_f32 v145, v146, v147
    ds_write_b64 v71, v[144:145] offset:64
    v_cvt_pk_bf16_f32 v32, v148, v149
    v_lshlrev_b32 v148, 16, v32
    v_and_b32 v149, 0xffff0000, v32
    v_cvt_pk_bf16_f32 v32, v150, v151
    v_lshlrev_b32 v150, 16, v32
    v_and_b32 v151, 0xffff0000, v32
    v_mul_f32 v148, 0x3d5105ec, v148
    v_mul_f32 v149, 0x3d5105ec, v149
    v_mul_f32 v150, 0x3d5105ec, v150
    v_mul_f32 v151, 0x3d5105ec, v151
    v_cvt_pk_bf16_f32 v148, v148, v149
    v_cvt_pk_bf16_f32 v149, v150, v151
    ds_write_b64 v71, v[148:149] offset:96
    v_cvt_pk_bf16_f32 v32, v152, v153
    v_lshlrev_b32 v152, 16, v32
    v_and_b32 v153, 0xffff0000, v32
    v_cvt_pk_bf16_f32 v32, v154, v155
    v_lshlrev_b32 v154, 16, v32
    v_and_b32 v155, 0xffff0000, v32
    v_mul_f32 v152, 0x3d5105ec, v152
    v_mul_f32 v153, 0x3d5105ec, v153
    v_mul_f32 v154, 0x3d5105ec, v154
    v_mul_f32 v155, 0x3d5105ec, v155
    v_cvt_pk_bf16_f32 v152, v152, v153
    v_cvt_pk_bf16_f32 v153, v154, v155
    ds_write_b64 v71, v[152:153] offset:2304
    v_cvt_pk_bf16_f32 v32, v156, v157
    v_lshlrev_b32 v156, 16, v32
    v_and_b32 v157, 0xffff0000, v32
    v_cvt_pk_bf16_f32 v32, v158, v159
    v_lshlrev_b32 v158, 16, v32
    v_and_b32 v159, 0xffff0000, v32
    v_mul_f32 v156, 0x3d5105ec, v156
    v_mul_f32 v157, 0x3d5105ec, v157
    v_mul_f32 v158, 0x3d5105ec, v158
    v_mul_f32 v159, 0x3d5105ec, v159
    v_cvt_pk_bf16_f32 v156, v156, v157
    v_cvt_pk_bf16_f32 v157, v158, v159
    ds_write_b64 v71, v[156:157] offset:2336
    v_cvt_pk_bf16_f32 v32, v160, v161
    v_lshlrev_b32 v160, 16, v32
    v_and_b32 v161, 0xffff0000, v32
    v_cvt_pk_bf16_f32 v32, v162, v163
    v_lshlrev_b32 v162, 16, v32
    v_and_b32 v163, 0xffff0000, v32
    v_mul_f32 v160, 0x3d5105ec, v160
    v_mul_f32 v161, 0x3d5105ec, v161
    v_mul_f32 v162, 0x3d5105ec, v162
    v_mul_f32 v163, 0x3d5105ec, v163
    v_cvt_pk_bf16_f32 v160, v160, v161
    v_cvt_pk_bf16_f32 v161, v162, v163
    ds_write_b64 v71, v[160:161] offset:2368
    v_cvt_pk_bf16_f32 v32, v164, v165
    v_lshlrev_b32 v164, 16, v32
    v_and_b32 v165, 0xffff0000, v32
    v_cvt_pk_bf16_f32 v32, v166, v167
    v_lshlrev_b32 v166, 16, v32
    v_and_b32 v167, 0xffff0000, v32
    v_mul_f32 v164, 0x3d5105ec, v164
    v_mul_f32 v165, 0x3d5105ec, v165
    v_mul_f32 v166, 0x3d5105ec, v166
    v_mul_f32 v167, 0x3d5105ec, v167
    v_cvt_pk_bf16_f32 v164, v164, v165
    v_cvt_pk_bf16_f32 v165, v166, v167
    ds_write_b64 v71, v[164:165] offset:2400
    v_cvt_pk_bf16_f32 v32, v168, v169
    v_lshlrev_b32 v168, 16, v32
    v_and_b32 v169, 0xffff0000, v32
    v_cvt_pk_bf16_f32 v32, v170, v171
    v_lshlrev_b32 v170, 16, v32
    v_and_b32 v171, 0xffff0000, v32
    v_mul_f32 v168, 0x3d5105ec, v168
    v_mul_f32 v169, 0x3d5105ec, v169
    v_mul_f32 v170, 0x3d5105ec, v170
    v_mul_f32 v171, 0x3d5105ec, v171
    v_cvt_pk_bf16_f32 v168, v168, v169
    v_cvt_pk_bf16_f32 v169, v170, v171
    ds_write_b64 v71, v[168:169] offset:4608
    v_cvt_pk_bf16_f32 v32, v172, v173
    v_lshlrev_b32 v172, 16, v32
    v_and_b32 v173, 0xffff0000, v32
    v_cvt_pk_bf16_f32 v32, v174, v175
    v_lshlrev_b32 v174, 16, v32
    v_and_b32 v175, 0xffff0000, v32
    v_mul_f32 v172, 0x3d5105ec, v172
    v_mul_f32 v173, 0x3d5105ec, v173
    v_mul_f32 v174, 0x3d5105ec, v174
    v_mul_f32 v175, 0x3d5105ec, v175
    v_cvt_pk_bf16_f32 v172, v172, v173
    v_cvt_pk_bf16_f32 v173, v174, v175
    ds_write_b64 v71, v[172:173] offset:4640
    v_cvt_pk_bf16_f32 v32, v176, v177
    v_lshlrev_b32 v176, 16, v32
    v_and_b32 v177, 0xffff0000, v32
    v_cvt_pk_bf16_f32 v32, v178, v179
    v_lshlrev_b32 v178, 16, v32
    v_and_b32 v179, 0xffff0000, v32
    v_mul_f32 v176, 0x3d5105ec, v176
    v_mul_f32 v177, 0x3d5105ec, v177
    v_mul_f32 v178, 0x3d5105ec, v178
    v_mul_f32 v179, 0x3d5105ec, v179
    v_cvt_pk_bf16_f32 v176, v176, v177
    v_cvt_pk_bf16_f32 v177, v178, v179
    ds_write_b64 v71, v[176:177] offset:4672
    v_cvt_pk_bf16_f32 v32, v180, v181
    v_lshlrev_b32 v180, 16, v32
    v_and_b32 v181, 0xffff0000, v32
    v_cvt_pk_bf16_f32 v32, v182, v183
    v_lshlrev_b32 v182, 16, v32
    v_and_b32 v183, 0xffff0000, v32
    v_mul_f32 v180, 0x3d5105ec, v180
    v_mul_f32 v181, 0x3d5105ec, v181
    v_mul_f32 v182, 0x3d5105ec, v182
    v_mul_f32 v183, 0x3d5105ec, v183
    v_cvt_pk_bf16_f32 v180, v180, v181
    v_cvt_pk_bf16_f32 v181, v182, v183
    ds_write_b64 v71, v[180:181] offset:4704
    v_cvt_pk_bf16_f32 v32, v184, v185
    v_lshlrev_b32 v184, 16, v32
    v_and_b32 v185, 0xffff0000, v32
    v_cvt_pk_bf16_f32 v32, v186, v187
    v_lshlrev_b32 v186, 16, v32
    v_and_b32 v187, 0xffff0000, v32
    v_mul_f32 v184, 0x3d5105ec, v184
    v_mul_f32 v185, 0x3d5105ec, v185
    v_mul_f32 v186, 0x3d5105ec, v186
    v_mul_f32 v187, 0x3d5105ec, v187
    v_cvt_pk_bf16_f32 v184, v184, v185
    v_cvt_pk_bf16_f32 v185, v186, v187
    ds_write_b64 v71, v[184:185] offset:6912
    v_cvt_pk_bf16_f32 v32, v188, v189
    v_lshlrev_b32 v188, 16, v32
    v_and_b32 v189, 0xffff0000, v32
    v_cvt_pk_bf16_f32 v32, v190, v191
    v_lshlrev_b32 v190, 16, v32
    v_and_b32 v191, 0xffff0000, v32
    v_mul_f32 v188, 0x3d5105ec, v188
    v_mul_f32 v189, 0x3d5105ec, v189
    v_mul_f32 v190, 0x3d5105ec, v190
    v_mul_f32 v191, 0x3d5105ec, v191
    v_cvt_pk_bf16_f32 v188, v188, v189
    v_cvt_pk_bf16_f32 v189, v190, v191
    ds_write_b64 v71, v[188:189] offset:6944
    v_cvt_pk_bf16_f32 v32, v192, v193
    v_lshlrev_b32 v192, 16, v32
    v_and_b32 v193, 0xffff0000, v32
    v_cvt_pk_bf16_f32 v32, v194, v195
    v_lshlrev_b32 v194, 16, v32
    v_and_b32 v195, 0xffff0000, v32
    v_mul_f32 v192, 0x3d5105ec, v192
    v_mul_f32 v193, 0x3d5105ec, v193
    v_mul_f32 v194, 0x3d5105ec, v194
    v_mul_f32 v195, 0x3d5105ec, v195
    v_cvt_pk_bf16_f32 v192, v192, v193
    v_cvt_pk_bf16_f32 v193, v194, v195
    ds_write_b64 v71, v[192:193] offset:6976
    v_cvt_pk_bf16_f32 v32, v196, v197
    v_lshlrev_b32 v196, 16, v32
    v_and_b32 v197, 0xffff0000, v32
    v_cvt_pk_bf16_f32 v32, v198, v199
    v_lshlrev_b32 v198, 16, v32
    v_and_b32 v199, 0xffff0000, v32
    v_mul_f32 v196, 0x3d5105ec, v196
    v_mul_f32 v197, 0x3d5105ec, v197
    v_mul_f32 v198, 0x3d5105ec, v198
    v_mul_f32 v199, 0x3d5105ec, v199
    v_cvt_pk_bf16_f32 v196, v196, v197
    v_cvt_pk_bf16_f32 v197, v198, v199
    ds_write_b64 v71, v[196:197] offset:7008
    s_waitcnt lgkmcnt(0)
    s_mov_b32 s36, 536870913
    s_mul_i32 s35, s33, 128
    s_lshr_b32 s37, s3, 1
    s_mul_i32 s37, s37, 64
    s_add_u32 s35, s35, s37
    s_mul_i32 s35, s35, 2048
    s_mul_i32 s37, s31, 256
    s_add_u32 s35, s35, s37
    s_and_b32 s37, s3, 1
    s_mul_i32 s37, s37, 128
    s_add_u32 s35, s35, s37
    s_mov_b32 s37, 2048
    v_add_u32 v27, 0, v2
    v_mul_hi_u32 v28, v27, s36
    v_mul_u32_u24 v29, 8, v28
    v_sub_u32 v29, v27, v29
    v_mul_u32_u24 v30, 144, v28
    v_lshl_add_u32 v30, v29, 4, v30
    v_add_u32 v30, s52, v30
    ds_read_b128 v[136:139], v30
    v_mul_lo_u32 v32, v28, s37
    v_lshl_add_u32 v34, v29, 4, v32
    s_waitcnt lgkmcnt(0)
    buffer_store_dwordx4 v[136:139], v34, s[20:23], s35 offen
    v_add_u32 v27, 64, v2
    v_mul_hi_u32 v28, v27, s36
    v_mul_u32_u24 v29, 8, v28
    v_sub_u32 v29, v27, v29
    v_mul_u32_u24 v30, 144, v28
    v_lshl_add_u32 v30, v29, 4, v30
    v_add_u32 v30, s52, v30
    ds_read_b128 v[140:143], v30
    v_mul_lo_u32 v32, v28, s37
    v_lshl_add_u32 v35, v29, 4, v32
    s_waitcnt lgkmcnt(0)
    buffer_store_dwordx4 v[140:143], v35, s[20:23], s35 offen
    v_add_u32 v27, 128, v2
    v_mul_hi_u32 v28, v27, s36
    v_mul_u32_u24 v29, 8, v28
    v_sub_u32 v29, v27, v29
    v_mul_u32_u24 v30, 144, v28
    v_lshl_add_u32 v30, v29, 4, v30
    v_add_u32 v30, s52, v30
    ds_read_b128 v[144:147], v30
    v_mul_lo_u32 v32, v28, s37
    v_lshl_add_u32 v36, v29, 4, v32
    s_waitcnt lgkmcnt(0)
    buffer_store_dwordx4 v[144:147], v36, s[20:23], s35 offen
    v_add_u32 v27, 192, v2
    v_mul_hi_u32 v28, v27, s36
    v_mul_u32_u24 v29, 8, v28
    v_sub_u32 v29, v27, v29
    v_mul_u32_u24 v30, 144, v28
    v_lshl_add_u32 v30, v29, 4, v30
    v_add_u32 v30, s52, v30
    ds_read_b128 v[148:151], v30
    v_mul_lo_u32 v32, v28, s37
    v_lshl_add_u32 v37, v29, 4, v32
    s_waitcnt lgkmcnt(0)
    buffer_store_dwordx4 v[148:151], v37, s[20:23], s35 offen
    v_add_u32 v27, 256, v2
    v_mul_hi_u32 v28, v27, s36
    v_mul_u32_u24 v29, 8, v28
    v_sub_u32 v29, v27, v29
    v_mul_u32_u24 v30, 144, v28
    v_lshl_add_u32 v30, v29, 4, v30
    v_add_u32 v30, s52, v30
    ds_read_b128 v[152:155], v30
    v_mul_lo_u32 v32, v28, s37
    v_lshl_add_u32 v38, v29, 4, v32
    s_waitcnt lgkmcnt(0)
    buffer_store_dwordx4 v[152:155], v38, s[20:23], s35 offen
    v_add_u32 v27, 320, v2
    v_mul_hi_u32 v28, v27, s36
    v_mul_u32_u24 v29, 8, v28
    v_sub_u32 v29, v27, v29
    v_mul_u32_u24 v30, 144, v28
    v_lshl_add_u32 v30, v29, 4, v30
    v_add_u32 v30, s52, v30
    ds_read_b128 v[156:159], v30
    v_mul_lo_u32 v32, v28, s37
    v_lshl_add_u32 v39, v29, 4, v32
    s_waitcnt lgkmcnt(0)
    buffer_store_dwordx4 v[156:159], v39, s[20:23], s35 offen
    v_add_u32 v27, 384, v2
    v_mul_hi_u32 v28, v27, s36
    v_mul_u32_u24 v29, 8, v28
    v_sub_u32 v29, v27, v29
    v_mul_u32_u24 v30, 144, v28
    v_lshl_add_u32 v30, v29, 4, v30
    v_add_u32 v30, s52, v30
    ds_read_b128 v[160:163], v30
    v_mul_lo_u32 v32, v28, s37
    v_lshl_add_u32 v40, v29, 4, v32
    s_waitcnt lgkmcnt(0)
    buffer_store_dwordx4 v[160:163], v40, s[20:23], s35 offen
    v_add_u32 v27, 448, v2
    v_mul_hi_u32 v28, v27, s36
    v_mul_u32_u24 v29, 8, v28
    v_sub_u32 v29, v27, v29
    v_mul_u32_u24 v30, 144, v28
    v_lshl_add_u32 v30, v29, 4, v30
    v_add_u32 v30, s52, v30
    ds_read_b128 v[164:167], v30
    v_mul_lo_u32 v32, v28, s37
    v_lshl_add_u32 v41, v29, 4, v32
    s_waitcnt lgkmcnt(0)
    buffer_store_dwordx4 v[164:167], v41, s[20:23], s35 offen
    s_waitcnt vmcnt(0)
L_dit_s_kernel_1:
    s_endpgm
.section .rodata,"a"
.p2align 6
.amdhsa_kernel dit_s_kernel
  .amdhsa_next_free_vgpr 200
  .amdhsa_next_free_sgpr 100
  .amdhsa_accum_offset 200
  .amdhsa_group_segment_fixed_size 0
  .amdhsa_kernarg_size 80
  .amdhsa_user_sgpr_count 2
  .amdhsa_user_sgpr_kernarg_segment_ptr 1
  .amdhsa_system_sgpr_workgroup_id_x 1
.end_amdhsa_kernel
.text
.globl dit_softmax_kernel
.p2align 8
.type dit_softmax_kernel,@function
dit_softmax_kernel:
    s_cmp_ge_u32 s2, 1024
    s_cbranch_scc1 L_dit_softmax_kernel_1
    s_load_dwordx2 s[8:9], s[0:1], 72
    v_lshrrev_b32 v1, 6, v0
    v_and_b32 v2, 63, v0
    s_nop 0
    v_readfirstlane_b32 s3, v1
    s_waitcnt lgkmcnt(0)
    s_add_u32 s12, s8, 16777216
    s_addc_u32 s13, s9, 0
    s_mov_b32 s14, 8388608
    s_mov_b32 s15, 0x00020000
    s_add_u32 s16, s8, 25165824
    s_addc_u32 s17, s9, 0
    s_mov_b32 s18, 8388608
    s_mov_b32 s19, 0x00020000
    s_lshl_b32 s24, s2, 2
    s_add_u32 s24, s24, s3
    s_lshl_b32 s26, s24, 11
    v_lshlrev_b32 v3, 4, v2
    buffer_load_dwordx4 v[4:7], v3, s[12:15], s26 offen
    buffer_load_dwordx4 v[8:11], v3, s[12:15], s26 offen offset:1024
    v_xor_b32 v64, 1, v2
    v_lshlrev_b32 v64, 2, v64
    v_xor_b32 v65, 2, v2
    v_lshlrev_b32 v65, 2, v65
    v_xor_b32 v66, 4, v2
    v_lshlrev_b32 v66, 2, v66
    v_xor_b32 v67, 8, v2
    v_lshlrev_b32 v67, 2, v67
    v_xor_b32 v68, 16, v2
    v_lshlrev_b32 v68, 2, v68
    v_xor_b32 v69, 32, v2
    v_lshlrev_b32 v69, 2, v69
    s_waitcnt vmcnt(0)
    v_lshlrev_b32 v12, 16, v4
    v_and_b32 v13, 0xffff0000, v4
    v_lshlrev_b32 v14, 16, v5
    v_and_b32 v15, 0xffff0000, v5
    v_lshlrev_b32 v16, 16, v6
    v_and_b32 v17, 0xffff0000, v6
    v_lshlrev_b32 v18, 16, v7
    v_and_b32 v19, 0xffff0000, v7
    v_lshlrev_b32 v20, 16, v8
    v_and_b32 v21, 0xffff0000, v8
    v_lshlrev_b32 v22, 16, v9
    v_and_b32 v23, 0xffff0000, v9
    v_lshlrev_b32 v24, 16, v10
    v_and_b32 v25, 0xffff0000, v10
    v_lshlrev_b32 v26, 16, v11
    v_and_b32 v27, 0xffff0000, v11
    v_max_f32 v30, v12, v13
    v_max_f32 v30, v30, v14
    v_max_f32 v30, v30, v15
    v_max_f32 v30, v30, v16
    v_max_f32 v30, v30, v17
    v_max_f32 v30, v30, v18
    v_max_f32 v30, v30, v19
    v_max_f32 v30, v30, v20
    v_max_f32 v30, v30, v21
    v_max_f32 v30, v30, v22
    v_max_f32 v30, v30, v23
    v_max_f32 v30, v30, v24
    v_max_f32 v30, v30, v25
    v_max_f32 v30, v30, v26
    v_max_f32 v30, v30, v27
    ds_bpermute_b32 v31, v64, v30
    s_waitcnt lgkmcnt(0)
    v_max_f32 v30, v30, v31
    ds_bpermute_b32 v31, v65, v30
    s_waitcnt lgkmcnt(0)
    v_max_f32 v30, v30, v31
    ds_bpermute_b32 v31, v66, v30
    s_waitcnt lgkmcnt(0)
    v_max_f32 v30, v30, v31
    ds_bpermute_b32 v31, v67, v30
    s_waitcnt lgkmcnt(0)
    v_max_f32 v30, v30, v31
    ds_bpermute_b32 v31, v68, v30
    s_waitcnt lgkmcnt(0)
    v_max_f32 v30, v30, v31
    ds_bpermute_b32 v31, v69, v30
    s_waitcnt lgkmcnt(0)
    v_max_f32 v30, v30, v31
    s_mov_b32 s27, 0x3fb8aa3b
    v_sub_f32 v12, v12, v30
    v_sub_f32 v13, v13, v30
    v_sub_f32 v14, v14, v30
    v_sub_f32 v15, v15, v30
    v_sub_f32 v16, v16, v30
    v_sub_f32 v17, v17, v30
    v_sub_f32 v18, v18, v30
    v_sub_f32 v19, v19, v30
    v_sub_f32 v20, v20, v30
    v_sub_f32 v21, v21, v30
    v_sub_f32 v22, v22, v30
    v_sub_f32 v23, v23, v30
    v_sub_f32 v24, v24, v30
    v_sub_f32 v25, v25, v30
    v_sub_f32 v26, v26, v30
    v_sub_f32 v27, v27, v30
    v_mul_f32 v12, s27, v12
    v_mul_f32 v13, s27, v13
    v_mul_f32 v14, s27, v14
    v_mul_f32 v15, s27, v15
    v_mul_f32 v16, s27, v16
    v_mul_f32 v17, s27, v17
    v_mul_f32 v18, s27, v18
    v_mul_f32 v19, s27, v19
    v_mul_f32 v20, s27, v20
    v_mul_f32 v21, s27, v21
    v_mul_f32 v22, s27, v22
    v_mul_f32 v23, s27, v23
    v_mul_f32 v24, s27, v24
    v_mul_f32 v25, s27, v25
    v_mul_f32 v26, s27, v26
    v_mul_f32 v27, s27, v27
    v_exp_f32 v12, v12
    v_exp_f32 v13, v13
    v_exp_f32 v14, v14
    v_exp_f32 v15, v15
    v_exp_f32 v16, v16
    v_exp_f32 v17, v17
    v_exp_f32 v18, v18
    v_exp_f32 v19, v19
    v_exp_f32 v20, v20
    v_exp_f32 v21, v21
    v_exp_f32 v22, v22
    v_exp_f32 v23, v23
    v_exp_f32 v24, v24
    v_exp_f32 v25, v25
    v_exp_f32 v26, v26
    v_exp_f32 v27, v27
    s_nop 0
    v_add_f32 v32, v12, v13
    v_add_f32 v32, v32, v14
    v_add_f32 v32, v32, v15
    v_add_f32 v32, v32, v16
    v_add_f32 v32, v32, v17
    v_add_f32 v32, v32, v18
    v_add_f32 v32, v32, v19
    v_add_f32 v32, v32, v20
    v_add_f32 v32, v32, v21
    v_add_f32 v32, v32, v22
    v_add_f32 v32, v32, v23
    v_add_f32 v32, v32, v24
    v_add_f32 v32, v32, v25
    v_add_f32 v32, v32, v26
    v_add_f32 v32, v32, v27
    ds_bpermute_b32 v31, v64, v32
    s_waitcnt lgkmcnt(0)
    v_add_f32 v32, v32, v31
    ds_bpermute_b32 v31, v65, v32
    s_waitcnt lgkmcnt(0)
    v_add_f32 v32, v32, v31
    ds_bpermute_b32 v31, v66, v32
    s_waitcnt lgkmcnt(0)
    v_add_f32 v32, v32, v31
    ds_bpermute_b32 v31, v67, v32
    s_waitcnt lgkmcnt(0)
    v_add_f32 v32, v32, v31
    ds_bpermute_b32 v31, v68, v32
    s_waitcnt lgkmcnt(0)
    v_add_f32 v32, v32, v31
    ds_bpermute_b32 v31, v69, v32
    s_waitcnt lgkmcnt(0)
    v_add_f32 v32, v32, v31
    v_rcp_f32 v32, v32
    s_nop 0
    v_mul_f32 v12, v12, v32
    v_mul_f32 v13, v13, v32
    v_mul_f32 v14, v14, v32
    v_mul_f32 v15, v15, v32
    v_mul_f32 v16, v16, v32
    v_mul_f32 v17, v17, v32
    v_mul_f32 v18, v18, v32
    v_mul_f32 v19, v19, v32
    v_mul_f32 v20, v20, v32
    v_mul_f32 v21, v21, v32
    v_mul_f32 v22, v22, v32
    v_mul_f32 v23, v23, v32
    v_mul_f32 v24, v24, v32
    v_mul_f32 v25, v25, v32
    v_mul_f32 v26, v26, v32
    v_mul_f32 v27, v27, v32
    v_cvt_pk_bf16_f32 v4, v12, v13
    v_cvt_pk_bf16_f32 v5, v14, v15
    v_cvt_pk_bf16_f32 v6, v16, v17
    v_cvt_pk_bf16_f32 v7, v18, v19
    v_cvt_pk_bf16_f32 v8, v20, v21
    v_cvt_pk_bf16_f32 v9, v22, v23
    v_cvt_pk_bf16_f32 v10, v24, v25
    v_cvt_pk_bf16_f32 v11, v26, v27
    buffer_store_dwordx4 v[4:7], v3, s[16:19], s26 offen
    buffer_store_dwordx4 v[8:11], v3, s[16:19], s26 offen offset:1024
    s_waitcnt vmcnt(0)
L_dit_softmax_kernel_1:
    s_endpgm
.section .rodata,"a"
.p2align 6
.amdhsa_kernel dit_softmax_kernel
  .amdhsa_next_free_vgpr 72
  .amdhsa_next_free_sgpr 100
  .amdhsa_accum_offset 72
  .amdhsa_group_segment_fixed_size 0
  .amdhsa_kernarg_size 80
  .amdhsa_user_sgpr_count 2
  .amdhsa_user_sgpr_kernarg_segment_ptr 1
  .amdhsa_system_sgpr_workgroup_id_x 1
.end_amdhsa_kernel
.text
.globl dit_pv_kernel
.p2align 8
.type dit_pv_kernel,@function
dit_pv_kernel:
    s_cmp_ge_u32 s2, 256
    s_cbranch_scc1 L_dit_pv_kernel_1
    s_load_dwordx2 s[4:5], s[0:1], 72
    s_load_dwordx2 s[6:7], s[0:1], 72
    s_load_dwordx2 s[8:9], s[0:1], 72
    s_load_dwordx2 s[10:11], s[0:1], 72
    s_and_b32 s54, s2, 7
    s_mul_i32 s54, s54, 32
    s_lshr_b32 s55, s2, 3
    s_add_u32 s54, s54, s55
    s_mul_hi_u32 s30, s54, 1073741825
    s_mul_i32 s31, s30, 4
    s_sub_u32 s31, s54, s31
    s_mul_hi_u32 s32, s30, 268435457
    s_mul_i32 s33, s32, 16
    s_sub_u32 s33, s30, s33
    v_lshrrev_b32 v1, 6, v0
    v_and_b32 v2, 63, v0
    s_nop 0
    v_readfirstlane_b32 s3, v1
    v_and_b32 v1, 3, v1
    s_lshr_b32 s53, s3, 2
    s_and_b32 s3, s3, 3
    s_waitcnt lgkmcnt(0)
    s_mul_i32 s34, s32, 2097152
    s_add_u32 s34, s34, 25165824
    s_add_u32 s12, s4, s34
    s_addc_u32 s13, s5, 0
    s_mov_b32 s14, 8388608
    s_mov_b32 s15, 0x00020000
    s_lshr_b32 s34, s32, 1
    s_mul_i32 s34, s34, 4718592
    s_and_b32 s43, s32, 1
    s_mul_i32 s43, s43, 768
    s_add_u32 s34, s34, s43
    s_add_u32 s34, s34, 4197376
    s_add_u32 s16, s6, s34
    s_addc_u32 s17, s7, 0
    s_mov_b32 s18, 9437184
    s_mov_b32 s19, 0x00020000
    s_lshr_b32 s34, s32, 1
    s_mul_i32 s34, s34, 1572864
    s_and_b32 s43, s32, 1
    s_mul_i32 s43, s43, 768
    s_add_u32 s34, s34, s43
    s_add_u32 s34, s34, 33554432
    s_add_u32 s20, s8, s34
    s_addc_u32 s21, s9, 0
    s_mov_b32 s22, 3145728
    s_mov_b32 s23, 0x00020000
    s_mov_b32 s24, s10
    s_mov_b32 s25, s11
    s_mov_b32 s26, 36864
    s_mov_b32 s27, 0x00020000
    v_lshrrev_b32 v27, 3, v2
    v_and_b32 v28, 7, v2
    v_xor_b32 v28, v28, v27
    s_mul_i32 s35, s33, 64
    s_lshl_b32 s36, s3, 3
    s_add_u32 s35, s35, s36
    v_add_u32 v29, s35, v27
    s_mov_b32 s36, 2048
    v_mul_lo_u32 v29, v29, s36
    v_lshl_add_u32 v4, v28, 4, v29
    s_mov_b32 s36, 357913942
    s_mul_i32 s35, s31, 192
    s_mov_b32 s37, 4608
    s_lshl_b32 s43, s3, 6
    v_add_u32 v29, s43, v2
    v_add_u32 v29, 0, v29
    v_mul_hi_u32 v30, v29, s36
    v_mul_u32_u24 v31, 12, v30
    v_sub_u32 v31, v29, v31
    v_bfe_u32 v33, v30, 3, 1
    v_mov_b32 v32, v33
    v_lshrrev_b32 v33, 1, v31
    v_xor_b32 v33, v33, v32
    v_and_b32 v31, 1, v31
    v_lshl_or_b32 v31, v33, 1, v31
    v_mul_lo_u32 v32, v30, s37
    v_lshl_add_u32 v32, v31, 4, v32
    v_add_u32 v5, s35, v32
    s_lshl_b32 s43, s3, 6
    v_add_u32 v29, s43, v2
    v_add_u32 v29, 256, v29
    v_mul_hi_u32 v30, v29, s36
    v_mul_u32_u24 v31, 12, v30
    v_sub_u32 v31, v29, v31
    v_bfe_u32 v33, v30, 3, 1
    v_mov_b32 v32, v33
    v_lshrrev_b32 v33, 1, v31
    v_xor_b32 v33, v33, v32
    v_and_b32 v31, 1, v31
    v_lshl_or_b32 v31, v33, 1, v31
    v_mul_lo_u32 v32, v30, s37
    v_lshl_add_u32 v32, v31, 4, v32
    v_add_u32 v6, s35, v32
    s_lshl_b32 s43, s3, 6
    v_add_u32 v29, s43, v2
    v_add_u32 v29, 512, v29
    v_mul_hi_u32 v30, v29, s36
    v_mul_u32_u24 v31, 12, v30
    v_sub_u32 v31, v29, v31
    v_bfe_u32 v33, v30, 3, 1
    v_mov_b32 v32, v33
    v_lshrrev_b32 v33, 1, v31
    v_xor_b32 v33, v33, v32
    v_and_b32 v31, 1, v31
    v_lshl_or_b32 v31, v33, 1, v31
    v_mul_lo_u32 v32, v30, s37
    v_lshl_add_u32 v32, v31, 4, v32
    v_add_u32 v7, s35, v32
    v_lshrrev_b32 v27, 1, v1
    v_and_b32 v28, 1, v1
    v_and_b32 v29, 15, v2
    v_lshrrev_b32 v30, 4, v2
    v_mul_u32_u24 v31, 32, v27
    v_add_u32 v31, v31, v29
    v_and_b32 v32, 7, v2
    v_xor_b32 v32, v32, v30
    v_lshlrev_b32 v32, 4, v32
    v_lshl_add_u32 v11, v31, 7, v32
    v_xor_b32 v12, 64, v11
    v_lshrrev_b32 v31, 2, v29
    v_lshl_add_u32 v31, v30, 3, v31
    v_bfe_u32 v33, v31, 3, 1
    v_mov_b32 v32, v33
    v_mul_u32_u24 v31, 192, v31
    v_and_b32 v33, 3, v2
    v_lshl_add_u32 v31, v33, 3, v31
    v_add_u32 v31, 8192, v31
    v_mul_u32_u24 v33, 3, v28
    v_add_u32 v33, 0, v33
    v_xor_b32 v33, v33, v32
    v_lshl_add_u32 v13, v33, 5, v31
    v_mul_u32_u24 v33, 3, v28
    v_add_u32 v33, 1, v33
    v_xor_b32 v33, v33, v32
    v_lshl_add_u32 v14, v33, 5, v31
    v_mul_u32_u24 v33, 3, v28
    v_add_u32 v33, 2, v33
    v_xor_b32 v33, v33, v32
    v_lshl_add_u32 v15, v33, 5, v31
    v_mov_b32 v112, 0
    v_mov_b32 v113, 0
    v_mov_b32 v114, 0
    v_mov_b32 v115, 0
    v_mov_b32 v116, 0
    v_mov_b32 v117, 0
    v_mov_b32 v118, 0
    v_mov_b32 v119, 0
    v_mov_b32 v120, 0
    v_mov_b32 v121, 0
    v_mov_b32 v122, 0
    v_mov_b32 v123, 0
    v_mov_b32 v124, 0
    v_mov_b32 v125, 0
    v_mov_b32 v126, 0
    v_mov_b32 v127, 0
    v_mov_b32 v128, 0
    v_mov_b32 v129, 0
    v_mov_b32 v130, 0
    v_mov_b32 v131, 0
    v_mov_b32 v132, 0
    v_mov_b32 v133, 0
    v_mov_b32 v134, 0
    v_mov_b32 v135, 0
    s_mov_b32 s38, 0
    s_mov_b32 s39, 0
    s_lshl_b32 s48, s3, 10
    s_mov_b32 s49, s48
    s_mov_b32 s50, 0
    s_mov_b32 s42, 10
    s_cmp_eq_u32 s53, 0
    s_cbranch_scc1 L_dit_pv_kernel_2
    s_add_u32 m0, s49, 0
    s_add_u32 s51, s38, 0
    buffer_load_dwordx4 v4, s[12:15], s51 offen lds
    s_add_u32 m0, s49, 4096
    s_add_u32 s51, s38, 65536
    buffer_load_dwordx4 v4, s[12:15], s51 offen lds
    s_add_u32 m0, s49, 8192
    s_nop 0
    buffer_load_dwordx4 v5, s[16:19], s39 offen lds
    s_add_u32 m0, s49, 12288
    s_nop 0
    buffer_load_dwordx4 v6, s[16:19], s39 offen lds
    s_add_u32 m0, s49, 16384
    s_nop 0
    buffer_load_dwordx4 v7, s[16:19], s39 offen lds
    s_add_u32 s38, s38, 128
    s_add_u32 s39, s39, 294912
    s_add_u32 s49, s49, 20480
    s_sub_u32 s51, s49, s48
    s_cmp_ge_u32 s51, 143360
    s_cselect_b32 s49, s48, s49
    s_add_u32 m0, s49, 0
    s_add_u32 s51, s38, 0
    buffer_load_dwordx4 v4, s[12:15], s51 offen lds
    s_add_u32 m0, s49, 4096
    s_add_u32 s51, s38, 65536
    buffer_load_dwordx4 v4, s[12:15], s51 offen lds
    s_add_u32 m0, s49, 8192
    s_nop 0
    buffer_load_dwordx4 v5, s[16:19], s39 offen lds
    s_add_u32 m0, s49, 12288
    s_nop 0
    buffer_load_dwordx4 v6, s[16:19], s39 offen lds
    s_add_u32 m0, s49, 16384
    s_nop 0
    buffer_load_dwordx4 v7, s[16:19], s39 offen lds
    s_add_u32 s38, s38, 128
    s_add_u32 s39, s39, 294912
    s_add_u32 s49, s49, 20480
    s_sub_u32 s51, s49, s48
    s_cmp_ge_u32 s51, 143360
    s_cselect_b32 s49, s48, s49
    s_add_u32 m0, s49, 0
    s_add_u32 s51, s38, 0
    buffer_load_dwordx4 v4, s[12:15], s51 offen lds
    s_add_u32 m0, s49, 4096
    s_add_u32 s51, s38, 65536
    buffer_load_dwordx4 v4, s[12:15], s51 offen lds
    s_add_u32 m0, s49, 8192
    s_nop 0
    buffer_load_dwordx4 v5, s[16:19], s39 offen lds
    s_add_u32 m0, s49, 12288
    s_nop 0
    buffer_load_dwordx4 v6, s[16:19], s39 offen lds
    s_add_u32 m0, s49, 16384
    s_nop 0
    buffer_load_dwordx4 v7, s[16:19], s39 offen lds
    s_add_u32 s38, s38, 128
    s_add_u32 s39, s39, 294912
    s_add_u32 s49, s49, 20480
    s_sub_u32 s51, s49, s48
    s_cmp_ge_u32 s51, 143360
    s_cselect_b32 s49, s48, s49
    s_add_u32 m0, s49, 0
    s_add_u32 s51, s38, 0
    buffer_load_dwordx4 v4, s[12:15], s51 offen lds
    s_add_u32 m0, s49, 4096
    s_add_u32 s51, s38, 65536
    buffer_load_dwordx4 v4, s[12:15], s51 offen lds
    s_add_u32 m0, s49, 8192
    s_nop 0
    buffer_load_dwordx4 v5, s[16:19], s39 offen lds
    s_add_u32 m0, s49, 12288
    s_nop 0
    buffer_load_dwordx4 v6, s[16:19], s39 offen lds
    s_add_u32 m0, s49, 16384
    s_nop 0
    buffer_load_dwordx4 v7, s[16:19], s39 offen lds
    s_add_u32 s38, s38, 128
    s_add_u32 s39, s39, 294912
    s_add_u32 s49, s49, 20480
    s_sub_u32 s51, s49, s48
    s_cmp_ge_u32 s51, 143360
    s_cselect_b32 s49, s48, s49
    s_add_u32 m0, s49, 0
    s_add_u32 s51, s38, 0
    buffer_load_dwordx4 v4, s[12:15], s51 offen lds
    s_add_u32 m0, s49, 4096
    s_add_u32 s51, s38, 65536
    buffer_load_dwordx4 v4, s[12:15], s51 offen lds
    s_add_u32 m0, s49, 8192
    s_nop 0
    buffer_load_dwordx4 v5, s[16:19], s39 offen lds
    s_add_u32 m0, s49, 12288
    s_nop 0
    buffer_load_dwordx4 v6, s[16:19], s39 offen lds
    s_add_u32 m0, s49, 16384
    s_nop 0
    buffer_load_dwordx4 v7, s[16:19], s39 offen lds
    s_add_u32 s38, s38, 128
    s_add_u32 s39, s39, 294912
    s_add_u32 s49, s49, 20480
    s_sub_u32 s51, s49, s48
    s_cmp_ge_u32 s51, 143360
    s_cselect_b32 s49, s48, s49
    s_add_u32 m0, s49, 0
    s_add_u32 s51, s38, 0
    buffer_load_dwordx4 v4, s[12:15], s51 offen lds
    s_add_u32 m0, s49, 4096
    s_add_u32 s51, s38, 65536
    buffer_load_dwordx4 v4, s[12:15], s51 offen lds
    s_add_u32 m0, s49, 8192
    s_nop 0
    buffer_load_dwordx4 v5, s[16:19], s39 offen lds
    s_add_u32 m0, s49, 12288
    s_nop 0
    buffer_load_dwordx4 v6, s[16:19], s39 offen lds
    s_add_u32 m0, s49, 16384
    s_nop 0
    buffer_load_dwordx4 v7, s[16:19], s39 offen lds
    s_add_u32 s38, s38, 128
    s_add_u32 s39, s39, 294912
    s_add_u32 s49, s49, 20480
    s_sub_u32 s51, s49, s48
    s_cmp_ge_u32 s51, 143360
    s_cselect_b32 s49, s48, s49
L_dit_pv_kernel_3:
    s_waitcnt vmcnt(25)
    s_barrier
    s_add_u32 m0, s49, 0
    s_add_u32 s51, s38, 0
    buffer_load_dwordx4 v4, s[12:15], s51 offen lds
    s_add_u32 m0, s49, 4096
    s_add_u32 s51, s38, 65536
    buffer_load_dwordx4 v4, s[12:15], s51 offen lds
    s_add_u32 m0, s49, 8192
    s_nop 0
    buffer_load_dwordx4 v5, s[16:19], s39 offen lds
    s_add_u32 m0, s49, 12288
    s_nop 0
    buffer_load_dwordx4 v6, s[16:19], s39 offen lds
    s_add_u32 m0, s49, 16384
    s_nop 0
    buffer_load_dwordx4 v7, s[16:19], s39 offen lds
    s_add_u32 s38, s38, 128
    s_add_u32 s39, s39, 294912
    s_add_u32 s49, s49, 20480
    s_sub_u32 s51, s49, s48
    s_cmp_ge_u32 s51, 143360
    s_cselect_b32 s49, s48, s49
    s_sub_u32 s42, s42, 1
    s_cmp_lg_u32 s42, 0
    s_cbranch_scc1 L_dit_pv_kernel_3
    s_waitcnt vmcnt(25)
    s_barrier
    s_waitcnt vmcnt(20)
    s_barrier
    s_waitcnt vmcnt(15)
    s_barrier
    s_waitcnt vmcnt(10)
    s_barrier
    s_waitcnt vmcnt(5)
    s_barrier
    s_waitcnt vmcnt(0)
    s_barrier
    s_barrier
    s_branch L_dit_pv_kernel_1
L_dit_pv_kernel_2:
    s_mov_b32 s42, 16
L_dit_pv_kernel_4:
    s_barrier
    v_add_u32 v19, s50, v11
    v_add_u32 v20, s50, v12
    v_add_u32 v21, s50, v13
    v_add_u32 v22, s50, v14
    v_add_u32 v23, s50, v15
    ds_read_b128 v[72:75], v19 offset:0
    ds_read_b128 v[76:79], v19 offset:2048
    ds_read_b64_tr_b16 v[88:89], v21 offset:0
    ds_read_b64_tr_b16 v[90:91], v21 offset:768
    ds_read_b64_tr_b16 v[92:93], v22 offset:0
    ds_read_b64_tr_b16 v[94:95], v22 offset:768
    ds_read_b64_tr_b16 v[96:97], v23 offset:0
    ds_read_b64_tr_b16 v[98:99], v23 offset:768
    ds_read_b128 v[80:83], v20 offset:0
    ds_read_b128 v[84:87], v20 offset:2048
    ds_read_b64_tr_b16 v[100:101], v21 offset:6144
    ds_read_b64_tr_b16 v[102:103], v21 offset:6912
    ds_read_b64_tr_b16 v[104:105], v22 offset:6144
    ds_read_b64_tr_b16 v[106:107], v22 offset:6912
    ds_read_b64_tr_b16 v[108:109], v23 offset:6144
    ds_read_b64_tr_b16 v[110:111], v23 offset:6912
    s_waitcnt lgkmcnt(8)
    v_mfma_f32_16x16x32_bf16 v[112:115], v[88:91], v[72:75], v[112:115]
    v_mfma_f32_16x16x32_bf16 v[116:119], v[92:95], v[72:75], v[116:119]
    v_mfma_f32_16x16x32_bf16 v[120:123], v[96:99], v[72:75], v[120:123]
    v_mfma_f32_16x16x32_bf16 v[124:127], v[88:91], v[76:79], v[124:127]
    v_mfma_f32_16x16x32_bf16 v[128:131], v[92:95], v[76:79], v[128:131]
    v_mfma_f32_16x16x32_bf16 v[132:135], v[96:99], v[76:79], v[132:135]
    s_waitcnt lgkmcnt(0)
    v_mfma_f32_16x16x32_bf16 v[112:115], v[100:103], v[80:83], v[112:115]
    v_mfma_f32_16x16x32_bf16 v[116:119], v[104:107], v[80:83], v[116:119]
    v_mfma_f32_16x16x32_bf16 v[120:123], v[108:111], v[80:83], v[120:123]
    v_mfma_f32_16x16x32_bf16 v[124:127], v[100:103], v[84:87], v[124:127]
    v_mfma_f32_16x16x32_bf16 v[128:131], v[104:107], v[84:87], v[128:131]
    v_mfma_f32_16x16x32_bf16 v[132:135], v[108:111], v[84:87], v[132:135]
    s_add_u32 s50, s50, 20480
    s_cmp_ge_u32 s50, 143360
    s_cselect_b32 s50, 0, s50
    s_sub_u32 s42, s42, 1
    s_cmp_lg_u32 s42, 0
    s_cbranch_scc1 L_dit_pv_kernel_4
    s_mul_i32 s35, s33, 64
    v_mul_u32_u24 v32, 32, v27
    v_add3_u32 v32, v32, v29, s35
    s_mul_i32 s36, s31, 96
    v_mul_u32_u24 v33, 48, v28
    v_lshl_add_u32 v33, v30, 2, v33
    v_add_u32 v33, s36, v33
    s_mov_b32 s37, 1536
    v_mul_lo_u32 v31, v32, s37
    v_lshl_add_u32 v31, v33, 1, v31
    s_barrier
    s_mul_i32 s52, s3, 3584
    v_mul_u32_u24 v71, 112, v29
    v_lshl_add_u32 v71, v30, 3, v71
    v_add_u32 v71, s52, v71
    s_nop 7
    s_nop 7
    v_cvt_pk_bf16_f32 v112, v112, v113
    v_cvt_pk_bf16_f32 v113, v114, v115
    ds_write_b64 v71, v[112:113] offset:0
    v_cvt_pk_bf16_f32 v116, v116, v117
    v_cvt_pk_bf16_f32 v117, v118, v119
    ds_write_b64 v71, v[116:117] offset:32
    v_cvt_pk_bf16_f32 v120, v120, v121
    v_cvt_pk_bf16_f32 v121, v122, v123
    ds_write_b64 v71, v[120:121] offset:64
    v_cvt_pk_bf16_f32 v124, v124, v125
    v_cvt_pk_bf16_f32 v125, v126, v127
    ds_write_b64 v71, v[124:125] offset:1792
    v_cvt_pk_bf16_f32 v128, v128, v129
    v_cvt_pk_bf16_f32 v129, v130, v131
    ds_write_b64 v71, v[128:129] offset:1824
    v_cvt_pk_bf16_f32 v132, v132, v133
    v_cvt_pk_bf16_f32 v133, v134, v135
    ds_write_b64 v71, v[132:133] offset:1856
    s_waitcnt lgkmcnt(0)
    s_mov_b32 s36, 715827883
    s_mul_i32 s35, s33, 64
    s_lshr_b32 s37, s3, 1
    s_mul_i32 s37, s37, 32
    s_add_u32 s35, s35, s37
    s_mul_i32 s35, s35, 1536
    s_mul_i32 s37, s31, 192
    s_add_u32 s35, s35, s37
    s_and_b32 s37, s3, 1
    s_mul_i32 s37, s37, 96
    s_add_u32 s35, s35, s37
    s_mov_b32 s37, 1536
    v_add_u32 v27, 0, v2
    v_mul_hi_u32 v28, v27, s36
    v_mul_u32_u24 v29, 6, v28
    v_sub_u32 v29, v27, v29
    v_mul_u32_u24 v30, 112, v28
    v_lshl_add_u32 v30, v29, 4, v30
    v_add_u32 v30, s52, v30
    ds_read_b128 v[112:115], v30
    v_mul_lo_u32 v32, v28, s37
    v_lshl_add_u32 v34, v29, 4, v32
    s_waitcnt lgkmcnt(0)
    buffer_store_dwordx4 v[112:115], v34, s[20:23], s35 offen
    v_add_u32 v27, 64, v2
    v_mul_hi_u32 v28, v27, s36
    v_mul_u32_u24 v29, 6, v28
    v_sub_u32 v29, v27, v29
    v_mul_u32_u24 v30, 112, v28
    v_lshl_add_u32 v30, v29, 4, v30
    v_add_u32 v30, s52, v30
    ds_read_b128 v[116:119], v30
    v_mul_lo_u32 v32, v28, s37
    v_lshl_add_u32 v35, v29, 4, v32
    s_waitcnt lgkmcnt(0)
    buffer_store_dwordx4 v[116:119], v35, s[20:23], s35 offen
    v_add_u32 v27, 128, v2
    v_mul_hi_u32 v28, v27, s36
    v_mul_u32_u24 v29, 6, v28
    v_sub_u32 v29, v27, v29
    v_mul_u32_u24 v30, 112, v28
    v_lshl_add_u32 v30, v29, 4, v30
    v_add_u32 v30, s52, v30
    ds_read_b128 v[120:123], v30
    v_mul_lo_u32 v32, v28, s37
    v_lshl_add_u32 v36, v29, 4, v32
    s_waitcnt lgkmcnt(0)
    buffer_store_dwordx4 v[120:123], v36, s[20:23], s35 offen
    s_waitcnt vmcnt(0)
L_dit_pv_kernel_1:
    s_endpgm
.section .rodata,"a"
.p2align 6
.amdhsa_kernel dit_pv_kernel
  .amdhsa_next_free_vgpr 136
  .amdhsa_next_free_sgpr 100
  .amdhsa_accum_offset 136
  .amdhsa_group_segment_fixed_size 0
  .amdhsa_kernarg_size 80
  .amdhsa_user_sgpr_count 2
  .amdhsa_user_sgpr_kernarg_segment_ptr 1
  .amdhsa_system_sgpr_workgroup_id_x 1
.end_amdhsa_kernel
.text
.globl dit_wo_kernel
.p2align 8
.type dit_wo_kernel,@function
dit_wo_kernel:
    s_cmp_ge_u32 s2, 256
    s_cbranch_scc1 L_dit_wo_kernel_1
    s_load_dwordx2 s[4:5], s[0:1], 72
    s_load_dwordx2 s[6:7], s[0:1], 24
    s_load_dwordx2 s[8:9], s[0:1], 72
    s_load_dwordx2 s[10:11], s[0:1], 72
    s_load_dwordx2 s[40:41], s[0:1], 0
    s_and_b32 s54, s2, 7
    s_mul_i32 s54, s54, 32
    s_lshr_b32 s55, s2, 3
    s_add_u32 s54, s54, s55
    s_mul_hi_u32 s30, s54, 536870913
    s_mul_i32 s31, s30, 8
    s_sub_u32 s31, s54, s31
    s_mul_hi_u32 s32, s30, 134217729
    s_mul_i32 s33, s32, 32
    s_sub_u32 s33, s30, s33
    v_lshrrev_b32 v1, 6, v0
    v_and_b32 v2, 63, v0
    s_nop 0
    v_readfirstlane_b32 s3, v1
    v_and_b32 v1, 3, v1
    s_lshr_b32 s53, s3, 2
    s_and_b32 s3, s3, 3
    s_waitcnt lgkmcnt(0)
    s_mul_i32 s34, s32, 0
    s_add_u32 s34, s34, 33554432
    s_add_u32 s12, s4, s34
    s_addc_u32 s13, s5, 0
    s_mov_b32 s14, 3145728
    s_mov_b32 s15, 0x00020000
    s_mul_i32 s34, s32, 0
    s_add_u32 s34, s34, 0
    s_add_u32 s16, s6, s34
    s_addc_u32 s17, s7, 0
    s_mov_b32 s18, 1179648
    s_mov_b32 s19, 0x00020000
    s_mul_i32 s34, s32, 0
    s_add_u32 s34, s34, 37748736
    s_add_u32 s20, s8, s34
    s_addc_u32 s21, s9, 0
    s_mov_b32 s22, 3145728
    s_mov_b32 s23, 0x00020000
    s_mov_b32 s24, s10
    s_mov_b32 s25, s11
    s_mov_b32 s26, 36864
    s_mov_b32 s27, 0x00020000
    s_mov_b32 s44, s40
    s_mov_b32 s45, s41
    s_mov_b32 s46, 3145728
    s_mov_b32 s47, 0x00020000
    v_lshrrev_b32 v27, 3, v2
    v_and_b32 v28, 7, v2
    v_xor_b32 v28, v28, v27
    s_mul_i32 s35, s33, 64
    s_lshl_b32 s36, s3, 3
    s_add_u32 s35, s35, s36
    v_add_u32 v29, s35, v27
    s_mov_b32 s36, 1536
    v_mul_lo_u32 v29, v29, s36
    v_lshl_add_u32 v4, v28, 4, v29
    s_mov_b32 s36, 357913942
    s_mul_i32 s35, s31, 192
    s_mov_b32 s37, 1536
    s_lshl_b32 s43, s3, 6
    v_add_u32 v29, s43, v2
    v_add_u32 v29, 0, v29
    v_mul_hi_u32 v30, v29, s36
    v_mul_u32_u24 v31, 12, v30
    v_sub_u32 v31, v29, v31
    v_bfe_u32 v33, v30, 3, 1
    v_mov_b32 v32, v33
    v_lshrrev_b32 v33, 1, v31
    v_xor_b32 v33, v33, v32
    v_and_b32 v31, 1, v31
    v_lshl_or_b32 v31, v33, 1, v31
    v_mul_lo_u32 v32, v30, s37
    v_lshl_add_u32 v32, v31, 4, v32
    v_add_u32 v5, s35, v32
    s_lshl_b32 s43, s3, 6
    v_add_u32 v29, s43, v2
    v_add_u32 v29, 256, v29
    v_mul_hi_u32 v30, v29, s36
    v_mul_u32_u24 v31, 12, v30
    v_sub_u32 v31, v29, v31
    v_bfe_u32 v33, v30, 3, 1
    v_mov_b32 v32, v33
    v_lshrrev_b32 v33, 1, v31
    v_xor_b32 v33, v33, v32
    v_and_b32 v31, 1, v31
    v_lshl_or_b32 v31, v33, 1, v31
    v_mul_lo_u32 v32, v30, s37
    v_lshl_add_u32 v32, v31, 4, v32
    v_add_u32 v6, s35, v32
    s_lshl_b32 s43, s3, 6
    v_add_u32 v29, s43, v2
    v_add_u32 v29, 512, v29
    v_mul_hi_u32 v30, v29, s36
    v_mul_u32_u24 v31, 12, v30
    v_sub_u32 v31, v29, v31
    v_bfe_u32 v33, v30, 3, 1
    v_mov_b32 v32, v33
    v_lshrrev_b32 v33, 1, v31
    v_xor_b32 v33, v33, v32
    v_and_b32 v31, 1, v31
    v_lshl_or_b32 v31, v33, 1, v31
    v_mul_lo_u32 v32, v30, s37
    v_lshl_add_u32 v32, v31, 4, v32
    v_add_u32 v7, s35, v32
    v_lshrrev_b32 v27, 1, v1
    v_and_b32 v28, 1, v1
    v_and_b32 v29, 15, v2
    v_lshrrev_b32 v30, 4, v2
    v_mul_u32_u24 v31, 32, v27
    v_add_u32 v31, v31, v29
    v_and_b32 v32, 7, v2
    v_xor_b32 v32, v32, v30
    v_lshlrev_b32 v32, 4, v32
    v_lshl_add_u32 v11, v31, 7, v32
    v_xor_b32 v12, 64, v11
    v_lshrrev_b32 v31, 2, v29
    v_lshl_add_u32 v31, v30, 3, v31
    v_bfe_u32 v33, v31, 3, 1
    v_mov_b32 v32, v33
    v_mul_u32_u24 v31, 192, v31
    v_and_b32 v33, 3, v2
    v_lshl_add_u32 v31, v33, 3, v31
    v_add_u32 v31, 8192, v31
    v_mul_u32_u24 v33, 3, v28
    v_add_u32 v33, 0, v33
    v_xor_b32 v33, v33, v32
    v_lshl_add_u32 v13, v33, 5, v31
    v_mul_u32_u24 v33, 3, v28
    v_add_u32 v33, 1, v33
    v_xor_b32 v33, v33, v32
    v_lshl_add_u32 v14, v33, 5, v31
    v_mul_u32_u24 v33, 3, v28
    v_add_u32 v33, 2, v33
    v_xor_b32 v33, v33, v32
    v_lshl_add_u32 v15, v33, 5, v31
    v_mov_b32 v112, 0
    v_mov_b32 v113, 0
    v_mov_b32 v114, 0
    v_mov_b32 v115, 0
    v_mov_b32 v116, 0
    v_mov_b32 v117, 0
    v_mov_b32 v118, 0
    v_mov_b32 v119, 0
    v_mov_b32 v120, 0
    v_mov_b32 v121, 0
    v_mov_b32 v122, 0
    v_mov_b32 v123, 0
    v_mov_b32 v124, 0
    v_mov_b32 v125, 0
    v_mov_b32 v126, 0
    v_mov_b32 v127, 0
    v_mov_b32 v128, 0
    v_mov_b32 v129, 0
    v_mov_b32 v130, 0
    v_mov_b32 v131, 0
    v_mov_b32 v132, 0
    v_mov_b32 v133, 0
    v_mov_b32 v134, 0
    v_mov_b32 v135, 0
    s_mov_b32 s38, 0
    s_mov_b32 s39, 0
    s_lshl_b32 s48, s3, 10
    s_mov_b32 s49, s48
    s_mov_b32 s50, 0
    s_mov_b32 s42, 6
    s_cmp_eq_u32 s53, 0
    s_cbranch_scc1 L_dit_wo_kernel_2
    s_add_u32 m0, s49, 0
    s_add_u32 s51, s38, 0
    buffer_load_dwordx4 v4, s[12:15], s51 offen lds
    s_add_u32 m0, s49, 4096
    s_add_u32 s51, s38, 49152
    buffer_load_dwordx4 v4, s[12:15], s51 offen lds
    s_add_u32 m0, s49, 8192
    s_nop 0
    buffer_load_dwordx4 v5, s[16:19], s39 offen lds
    s_add_u32 m0, s49, 12288
    s_nop 0
    buffer_load_dwordx4 v6, s[16:19], s39 offen lds
    s_add_u32 m0, s49, 16384
    s_nop 0
    buffer_load_dwordx4 v7, s[16:19], s39 offen lds
    s_add_u32 s38, s38, 128
    s_add_u32 s39, s39, 98304
    s_add_u32 s49, s49, 20480
    s_sub_u32 s51, s49, s48
    s_cmp_ge_u32 s51, 143360
    s_cselect_b32 s49, s48, s49
    s_add_u32 m0, s49, 0
    s_add_u32 s51, s38, 0
    buffer_load_dwordx4 v4, s[12:15], s51 offen lds
    s_add_u32 m0, s49, 4096
    s_add_u32 s51, s38, 49152
    buffer_load_dwordx4 v4, s[12:15], s51 offen lds
    s_add_u32 m0, s49, 8192
    s_nop 0
    buffer_load_dwordx4 v5, s[16:19], s39 offen lds
    s_add_u32 m0, s49, 12288
    s_nop 0
    buffer_load_dwordx4 v6, s[16:19], s39 offen lds
    s_add_u32 m0, s49, 16384
    s_nop 0
    buffer_load_dwordx4 v7, s[16:19], s39 offen lds
    s_add_u32 s38, s38, 128
    s_add_u32 s39, s39, 98304
    s_add_u32 s49, s49, 20480
    s_sub_u32 s51, s49, s48
    s_cmp_ge_u32 s51, 143360
    s_cselect_b32 s49, s48, s49
    s_add_u32 m0, s49, 0
    s_add_u32 s51, s38, 0
    buffer_load_dwordx4 v4, s[12:15], s51 offen lds
    s_add_u32 m0, s49, 4096
    s_add_u32 s51, s38, 49152
    buffer_load_dwordx4 v4, s[12:15], s51 offen lds
    s_add_u32 m0, s49, 8192
    s_nop 0
    buffer_load_dwordx4 v5, s[16:19], s39 offen lds
    s_add_u32 m0, s49, 12288
    s_nop 0
    buffer_load_dwordx4 v6, s[16:19], s39 offen lds
    s_add_u32 m0, s49, 16384
    s_nop 0
    buffer_load_dwordx4 v7, s[16:19], s39 offen lds
    s_add_u32 s38, s38, 128
    s_add_u32 s39, s39, 98304
    s_add_u32 s49, s49, 20480
    s_sub_u32 s51, s49, s48
    s_cmp_ge_u32 s51, 143360
    s_cselect_b32 s49, s48, s49
    s_add_u32 m0, s49, 0
    s_add_u32 s51, s38, 0
    buffer_load_dwordx4 v4, s[12:15], s51 offen lds
    s_add_u32 m0, s49, 4096
    s_add_u32 s51, s38, 49152
    buffer_load_dwordx4 v4, s[12:15], s51 offen lds
    s_add_u32 m0, s49, 8192
    s_nop 0
    buffer_load_dwordx4 v5, s[16:19], s39 offen lds
    s_add_u32 m0, s49, 12288
    s_nop 0
    buffer_load_dwordx4 v6, s[16:19], s39 offen lds
    s_add_u32 m0, s49, 16384
    s_nop 0
    buffer_load_dwordx4 v7, s[16:19], s39 offen lds
    s_add_u32 s38, s38, 128
    s_add_u32 s39, s39, 98304
    s_add_u32 s49, s49, 20480
    s_sub_u32 s51, s49, s48
    s_cmp_ge_u32 s51, 143360
    s_cselect_b32 s49, s48, s49
    s_add_u32 m0, s49, 0
    s_add_u32 s51, s38, 0
    buffer_load_dwordx4 v4, s[12:15], s51 offen lds
    s_add_u32 m0, s49, 4096
    s_add_u32 s51, s38, 49152
    buffer_load_dwordx4 v4, s[12:15], s51 offen lds
    s_add_u32 m0, s49, 8192
    s_nop 0
    buffer_load_dwordx4 v5, s[16:19], s39 offen lds
    s_add_u32 m0, s49, 12288
    s_nop 0
    buffer_load_dwordx4 v6, s[16:19], s39 offen lds
    s_add_u32 m0, s49, 16384
    s_nop 0
    buffer_load_dwordx4 v7, s[16:19], s39 offen lds
    s_add_u32 s38, s38, 128
    s_add_u32 s39, s39, 98304
    s_add_u32 s49, s49, 20480
    s_sub_u32 s51, s49, s48
    s_cmp_ge_u32 s51, 143360
    s_cselect_b32 s49, s48, s49
    s_add_u32 m0, s49, 0
    s_add_u32 s51, s38, 0
    buffer_load_dwordx4 v4, s[12:15], s51 offen lds
    s_add_u32 m0, s49, 4096
    s_add_u32 s51, s38, 49152
    buffer_load_dwordx4 v4, s[12:15], s51 offen lds
    s_add_u32 m0, s49, 8192
    s_nop 0
    buffer_load_dwordx4 v5, s[16:19], s39 offen lds
    s_add_u32 m0, s49, 12288
    s_nop 0
    buffer_load_dwordx4 v6, s[16:19], s39 offen lds
    s_add_u32 m0, s49, 16384
    s_nop 0
    buffer_load_dwordx4 v7, s[16:19], s39 offen lds
    s_add_u32 s38, s38, 128
    s_add_u32 s39, s39, 98304
    s_add_u32 s49, s49, 20480
    s_sub_u32 s51, s49, s48
    s_cmp_ge_u32 s51, 143360
    s_cselect_b32 s49, s48, s49
L_dit_wo_kernel_3:
    s_waitcnt vmcnt(25)
    s_barrier
    s_add_u32 m0, s49, 0
    s_add_u32 s51, s38, 0
    buffer_load_dwordx4 v4, s[12:15], s51 offen lds
    s_add_u32 m0, s49, 4096
    s_add_u32 s51, s38, 49152
    buffer_load_dwordx4 v4, s[12:15], s51 offen lds
    s_add_u32 m0, s49, 8192
    s_nop 0
    buffer_load_dwordx4 v5, s[16:19], s39 offen lds
    s_add_u32 m0, s49, 12288
    s_nop 0
    buffer_load_dwordx4 v6, s[16:19], s39 offen lds
    s_add_u32 m0, s49, 16384
    s_nop 0
    buffer_load_dwordx4 v7, s[16:19], s39 offen lds
    s_add_u32 s38, s38, 128
    s_add_u32 s39, s39, 98304
    s_add_u32 s49, s49, 20480
    s_sub_u32 s51, s49, s48
    s_cmp_ge_u32 s51, 143360
    s_cselect_b32 s49, s48, s49
    s_sub_u32 s42, s42, 1
    s_cmp_lg_u32 s42, 0
    s_cbranch_scc1 L_dit_wo_kernel_3
    s_waitcnt vmcnt(25)
    s_barrier
    s_waitcnt vmcnt(20)
    s_barrier
    s_waitcnt vmcnt(15)
    s_barrier
    s_waitcnt vmcnt(10)
    s_barrier
    s_waitcnt vmcnt(5)
    s_barrier
    s_waitcnt vmcnt(0)
    s_barrier
    s_barrier
    s_branch L_dit_wo_kernel_1
L_dit_wo_kernel_2:
    s_mov_b32 s42, 12
L_dit_wo_kernel_4:
    s_barrier
    v_add_u32 v19, s50, v11
    v_add_u32 v20, s50, v12
    v_add_u32 v21, s50, v13
    v_add_u32 v22, s50, v14
    v_add_u32 v23, s50, v15
    ds_read_b128 v[72:75], v19 offset:0
    ds_read_b128 v[76:79], v19 offset:2048
    ds_read_b64_tr_b16 v[88:89], v21 offset:0
    ds_read_b64_tr_b16 v[90:91], v21 offset:768
    ds_read_b64_tr_b16 v[92:93], v22 offset:0
    ds_read_b64_tr_b16 v[94:95], v22 offset:768
    ds_read_b64_tr_b16 v[96:97], v23 offset:0
    ds_read_b64_tr_b16 v[98:99], v23 offset:768
    ds_read_b128 v[80:83], v20 offset:0
    ds_read_b128 v[84:87], v20 offset:2048
    ds_read_b64_tr_b16 v[100:101], v21 offset:6144
    ds_read_b64_tr_b16 v[102:103], v21 offset:6912
    ds_read_b64_tr_b16 v[104:105], v22 offset:6144
    ds_read_b64_tr_b16 v[106:107], v22 offset:6912
    ds_read_b64_tr_b16 v[108:109], v23 offset:6144
    ds_read_b64_tr_b16 v[110:111], v23 offset:6912
    s_waitcnt lgkmcnt(8)
    v_mfma_f32_16x16x32_bf16 v[112:115], v[88:91], v[72:75], v[112:115]
    v_mfma_f32_16x16x32_bf16 v[116:119], v[92:95], v[72:75], v[116:119]
    v_mfma_f32_16x16x32_bf16 v[120:123], v[96:99], v[72:75], v[120:123]
    v_mfma_f32_16x16x32_bf16 v[124:127], v[88:91], v[76:79], v[124:127]
    v_mfma_f32_16x16x32_bf16 v[128:131], v[92:95], v[76:79], v[128:131]
    v_mfma_f32_16x16x32_bf16 v[132:135], v[96:99], v[76:79], v[132:135]
    s_waitcnt lgkmcnt(0)
    v_mfma_f32_16x16x32_bf16 v[112:115], v[100:103], v[80:83], v[112:115]
    v_mfma_f32_16x16x32_bf16 v[116:119], v[104:107], v[80:83], v[116:119]
    v_mfma_f32_16x16x32_bf16 v[120:123], v[108:111], v[80:83], v[120:123]
    v_mfma_f32_16x16x32_bf16 v[124:127], v[100:103], v[84:87], v[124:127]
    v_mfma_f32_16x16x32_bf16 v[128:131], v[104:107], v[84:87], v[128:131]
    v_mfma_f32_16x16x32_bf16 v[132:135], v[108:111], v[84:87], v[132:135]
    s_add_u32 s50, s50, 20480
    s_cmp_ge_u32 s50, 143360
    s_cselect_b32 s50, 0, s50
    s_sub_u32 s42, s42, 1
    s_cmp_lg_u32 s42, 0
    s_cbranch_scc1 L_dit_wo_kernel_4
    s_mul_i32 s35, s33, 64
    v_mul_u32_u24 v32, 32, v27
    v_add3_u32 v32, v32, v29, s35
    s_mul_i32 s36, s31, 96
    v_mul_u32_u24 v33, 48, v28
    v_lshl_add_u32 v33, v30, 2, v33
    v_add_u32 v33, s36, v33
    s_mov_b32 s37, 1536
    v_mul_lo_u32 v31, v32, s37
    v_lshl_add_u32 v31, v33, 1, v31
    s_barrier
    s_mul_i32 s52, s3, 3584
    v_mul_u32_u24 v71, 112, v29
    v_lshl_add_u32 v71, v30, 3, v71
    v_add_u32 v71, s52, v71
    s_lshr_b32 s37, s35, 10
    s_mul_i32 s37, s37, 18432
    s_add_u32 s37, s37, 6144
    v_lshlrev_b32 v33, 2, v33
    buffer_load_dwordx4 v[34:37], v33, s[24:27], s37 offen offset:0
    buffer_load_dwordx4 v[38:41], v33, s[24:27], s37 offen offset:64
    buffer_load_dwordx4 v[42:45], v33, s[24:27], s37 offen offset:128
    s_nop 7
    s_nop 7
    buffer_load_dwordx2 v[46:47], v31, s[44:47], 0 offen offset:0
    buffer_load_dwordx2 v[48:49], v31, s[44:47], 0 offen offset:32
    buffer_load_dwordx2 v[50:51], v31, s[44:47], 0 offen offset:64
    s_waitcnt vmcnt(0)
    v_cvt_pk_bf16_f32 v32, v112, v113
    v_lshlrev_b32 v112, 16, v32
    v_and_b32 v113, 0xffff0000, v32
    v_cvt_pk_bf16_f32 v32, v114, v115
    v_lshlrev_b32 v114, 16, v32
    v_and_b32 v115, 0xffff0000, v32
    v_mul_f32 v112, v112, v34
    v_mul_f32 v113, v113, v35
    v_mul_f32 v114, v114, v36
    v_mul_f32 v115, v115, v37
    v_cvt_pk_bf16_f32 v32, v112, v113
    v_lshlrev_b32 v112, 16, v32
    v_and_b32 v113, 0xffff0000, v32
    v_cvt_pk_bf16_f32 v32, v114, v115
    v_lshlrev_b32 v114, 16, v32
    v_and_b32 v115, 0xffff0000, v32
    v_lshlrev_b32 v32, 16, v46
    v_add_f32 v112, v112, v32
    v_and_b32 v32, 0xffff0000, v46
    v_add_f32 v113, v113, v32
    v_lshlrev_b32 v32, 16, v47
    v_add_f32 v114, v114, v32
    v_and_b32 v32, 0xffff0000, v47
    v_add_f32 v115, v115, v32
    v_cvt_pk_bf16_f32 v112, v112, v113
    v_cvt_pk_bf16_f32 v113, v114, v115
    ds_write_b64 v71, v[112:113] offset:0
    v_cvt_pk_bf16_f32 v32, v116, v117
    v_lshlrev_b32 v116, 16, v32
    v_and_b32 v117, 0xffff0000, v32
    v_cvt_pk_bf16_f32 v32, v118, v119
    v_lshlrev_b32 v118, 16, v32
    v_and_b32 v119, 0xffff0000, v32
    v_mul_f32 v116, v116, v38
    v_mul_f32 v117, v117, v39
    v_mul_f32 v118, v118, v40
    v_mul_f32 v119, v119, v41
    v_cvt_pk_bf16_f32 v32, v116, v117
    v_lshlrev_b32 v116, 16, v32
    v_and_b32 v117, 0xffff0000, v32
    v_cvt_pk_bf16_f32 v32, v118, v119
    v_lshlrev_b32 v118, 16, v32
    v_and_b32 v119, 0xffff0000, v32
    v_lshlrev_b32 v32, 16, v48
    v_add_f32 v116, v116, v32
    v_and_b32 v32, 0xffff0000, v48
    v_add_f32 v117, v117, v32
    v_lshlrev_b32 v32, 16, v49
    v_add_f32 v118, v118, v32
    v_and_b32 v32, 0xffff0000, v49
    v_add_f32 v119, v119, v32
    v_cvt_pk_bf16_f32 v116, v116, v117
    v_cvt_pk_bf16_f32 v117, v118, v119
    ds_write_b64 v71, v[116:117] offset:32
    v_cvt_pk_bf16_f32 v32, v120, v121
    v_lshlrev_b32 v120, 16, v32
    v_and_b32 v121, 0xffff0000, v32
    v_cvt_pk_bf16_f32 v32, v122, v123
    v_lshlrev_b32 v122, 16, v32
    v_and_b32 v123, 0xffff0000, v32
    v_mul_f32 v120, v120, v42
    v_mul_f32 v121, v121, v43
    v_mul_f32 v122, v122, v44
    v_mul_f32 v123, v123, v45
    v_cvt_pk_bf16_f32 v32, v120, v121
    v_lshlrev_b32 v120, 16, v32
    v_and_b32 v121, 0xffff0000, v32
    v_cvt_pk_bf16_f32 v32, v122, v123
    v_lshlrev_b32 v122, 16, v32
    v_and_b32 v123, 0xffff0000, v32
    v_lshlrev_b32 v32, 16, v50
    v_add_f32 v120, v120, v32
    v_and_b32 v32, 0xffff0000, v50
    v_add_f32 v121, v121, v32
    v_lshlrev_b32 v32, 16, v51
    v_add_f32 v122, v122, v32
    v_and_b32 v32, 0xffff0000, v51
    v_add_f32 v123, v123, v32
    v_cvt_pk_bf16_f32 v120, v120, v121
    v_cvt_pk_bf16_f32 v121, v122, v123
    ds_write_b64 v71, v[120:121] offset:64
    v_add_u32 v31, 24576, v31
    buffer_load_dwordx2 v[46:47], v31, s[44:47], 0 offen offset:0
    buffer_load_dwordx2 v[48:49], v31, s[44:47], 0 offen offset:32
    buffer_load_dwordx2 v[50:51], v31, s[44:47], 0 offen offset:64
    s_waitcnt vmcnt(0)
    v_cvt_pk_bf16_f32 v32, v124, v125
    v_lshlrev_b32 v124, 16, v32
    v_and_b32 v125, 0xffff0000, v32
    v_cvt_pk_bf16_f32 v32, v126, v127
    v_lshlrev_b32 v126, 16, v32
    v_and_b32 v127, 0xffff0000, v32
    v_mul_f32 v124, v124, v34
    v_mul_f32 v125, v125, v35
    v_mul_f32 v126, v126, v36
    v_mul_f32 v127, v127, v37
    v_cvt_pk_bf16_f32 v32, v124, v125
    v_lshlrev_b32 v124, 16, v32
    v_and_b32 v125, 0xffff0000, v32
    v_cvt_pk_bf16_f32 v32, v126, v127
    v_lshlrev_b32 v126, 16, v32
    v_and_b32 v127, 0xffff0000, v32
    v_lshlrev_b32 v32, 16, v46
    v_add_f32 v124, v124, v32
    v_and_b32 v32, 0xffff0000, v46
    v_add_f32 v125, v125, v32
    v_lshlrev_b32 v32, 16, v47
    v_add_f32 v126, v126, v32
    v_and_b32 v32, 0xffff0000, v47
    v_add_f32 v127, v127, v32
    v_cvt_pk_bf16_f32 v124, v124, v125
    v_cvt_pk_bf16_f32 v125, v126, v127
    ds_write_b64 v71, v[124:125] offset:1792
    v_cvt_pk_bf16_f32 v32, v128, v129
    v_lshlrev_b32 v128, 16, v32
    v_and_b32 v129, 0xffff0000, v32
    v_cvt_pk_bf16_f32 v32, v130, v131
    v_lshlrev_b32 v130, 16, v32
    v_and_b32 v131, 0xffff0000, v32
    v_mul_f32 v128, v128, v38
    v_mul_f32 v129, v129, v39
    v_mul_f32 v130, v130, v40
    v_mul_f32 v131, v131, v41
    v_cvt_pk_bf16_f32 v32, v128, v129
    v_lshlrev_b32 v128, 16, v32
    v_and_b32 v129, 0xffff0000, v32
    v_cvt_pk_bf16_f32 v32, v130, v131
    v_lshlrev_b32 v130, 16, v32
    v_and_b32 v131, 0xffff0000, v32
    v_lshlrev_b32 v32, 16, v48
    v_add_f32 v128, v128, v32
    v_and_b32 v32, 0xffff0000, v48
    v_add_f32 v129, v129, v32
    v_lshlrev_b32 v32, 16, v49
    v_add_f32 v130, v130, v32
    v_and_b32 v32, 0xffff0000, v49
    v_add_f32 v131, v131, v32
    v_cvt_pk_bf16_f32 v128, v128, v129
    v_cvt_pk_bf16_f32 v129, v130, v131
    ds_write_b64 v71, v[128:129] offset:1824
    v_cvt_pk_bf16_f32 v32, v132, v133
    v_lshlrev_b32 v132, 16, v32
    v_and_b32 v133, 0xffff0000, v32
    v_cvt_pk_bf16_f32 v32, v134, v135
    v_lshlrev_b32 v134, 16, v32
    v_and_b32 v135, 0xffff0000, v32
    v_mul_f32 v132, v132, v42
    v_mul_f32 v133, v133, v43
    v_mul_f32 v134, v134, v44
    v_mul_f32 v135, v135, v45
    v_cvt_pk_bf16_f32 v32, v132, v133
    v_lshlrev_b32 v132, 16, v32
    v_and_b32 v133, 0xffff0000, v32
    v_cvt_pk_bf16_f32 v32, v134, v135
    v_lshlrev_b32 v134, 16, v32
    v_and_b32 v135, 0xffff0000, v32
    v_lshlrev_b32 v32, 16, v50
    v_add_f32 v132, v132, v32
    v_and_b32 v32, 0xffff0000, v50
    v_add_f32 v133, v133, v32
    v_lshlrev_b32 v32, 16, v51
    v_add_f32 v134, v134, v32
    v_and_b32 v32, 0xffff0000, v51
    v_add_f32 v135, v135, v32
    v_cvt_pk_bf16_f32 v132, v132, v133
    v_cvt_pk_bf16_f32 v133, v134, v135
    ds_write_b64 v71, v[132:133] offset:1856
    s_waitcnt lgkmcnt(0)
    s_mov_b32 s36, 715827883
    s_mul_i32 s35, s33, 64
    s_lshr_b32 s37, s3, 1
    s_mul_i32 s37, s37, 32
    s_add_u32 s35, s35, s37
    s_mul_i32 s35, s35, 1536
    s_mul_i32 s37, s31, 192
    s_add_u32 s35, s35, s37
    s_and_b32 s37, s3, 1
    s_mul_i32 s37, s37, 96
    s_add_u32 s35, s35, s37
    s_mov_b32 s37, 1536
    v_add_u32 v27, 0, v2
    v_mul_hi_u32 v28, v27, s36
    v_mul_u32_u24 v29, 6, v28
    v_sub_u32 v29, v27, v29
    v_mul_u32_u24 v30, 112, v28
    v_lshl_add_u32 v30, v29, 4, v30
    v_add_u32 v30, s52, v30
    ds_read_b128 v[112:115], v30
    v_mul_lo_u32 v32, v28, s37
    v_lshl_add_u32 v34, v29, 4, v32
    s_waitcnt lgkmcnt(0)
    buffer_store_dwordx4 v[112:115], v34, s[20:23], s35 offen
    v_add_u32 v27, 64, v2
    v_mul_hi_u32 v28, v27, s36
    v_mul_u32_u24 v29, 6, v28
    v_sub_u32 v29, v27, v29
    v_mul_u32_u24 v30, 112, v28
    v_lshl_add_u32 v30, v29, 4, v30
    v_add_u32 v30, s52, v30
    ds_read_b128 v[116:119], v30
    v_mul_lo_u32 v32, v28, s37
    v_lshl_add_u32 v35, v29, 4, v32
    s_waitcnt lgkmcnt(0)
    buffer_store_dwordx4 v[116:119], v35, s[20:23], s35 offen
    v_add_u32 v27, 128, v2
    v_mul_hi_u32 v28, v27, s36
    v_mul_u32_u24 v29, 6, v28
    v_sub_u32 v29, v27, v29
    v_mul_u32_u24 v30, 112, v28
    v_lshl_add_u32 v30, v29, 4, v30
    v_add_u32 v30, s52, v30
    ds_read_b128 v[120:123], v30
    v_mul_lo_u32 v32, v28, s37
    v_lshl_add_u32 v36, v29, 4, v32
    s_waitcnt lgkmcnt(0)
    buffer_store_dwordx4 v[120:123], v36, s[20:23], s35 offen
    s_waitcnt vmcnt(0)
L_dit_wo_kernel_1:
    s_endpgm
.section .rodata,"a"
.p2align 6
.amdhsa_kernel dit_wo_kernel
  .amdhsa_next_free_vgpr 136
  .amdhsa_next_free_sgpr 100
  .amdhsa_accum_offset 136
  .amdhsa_group_segment_fixed_size 0
  .amdhsa_kernarg_size 80
  .amdhsa_user_sgpr_count 2
  .amdhsa_user_sgpr_kernarg_segment_ptr 1
  .amdhsa_system_sgpr_workgroup_id_x 1
.end_amdhsa_kernel
.text
.globl dit_ln2_kernel
.p2align 8
.type dit_ln2_kernel,@function
dit_ln2_kernel:
    s_cmp_ge_u32 s2, 512
    s_cbranch_scc1 L_dit_ln2_kernel_1
    s_load_dwordx2 s[4:5], s[0:1], 0
    s_load_dwordx2 s[8:9], s[0:1], 72
    v_lshrrev_b32 v1, 6, v0
    v_and_b32 v2, 63, v0
    s_nop 0
    v_readfirstlane_b32 s3, v1
    s_waitcnt lgkmcnt(0)
    s_add_u32 s12, s8, 37748736
    s_addc_u32 s13, s9, 0
    s_mov_b32 s14, 3145728
    s_mov_b32 s15, 0x00020000
    s_mov_b32 s16, s8
    s_mov_b32 s17, s9
    s_mov_b32 s18, 36864
    s_mov_b32 s19, 0x00020000
    s_add_u32 s20, s8, 41943040
    s_addc_u32 s21, s9, 0
    s_mov_b32 s22, 3145728
    s_mov_b32 s23, 0x00020000
    s_lshl_b32 s24, s2, 2
    s_add_u32 s24, s24, s3
    s_lshr_b32 s25, s24, 10
    s_mul_i32 s26, s24, 1536
    v_lshlrev_b32 v3, 3, v2
    buffer_load_dwordx2 v[4:5], v3, s[12:15], s26 offen
    buffer_load_dwordx2 v[6:7], v3, s[12:15], s26 offen offset:512
    buffer_load_dwordx2 v[8:9], v3, s[12:15], s26 offen offset:1024
    s_mul_i32 s27, s25, 18432
    s_add_u32 s28, s27, 9216
    s_add_u32 s29, s27, 12288
    v_lshlrev_b32 v10, 4, v2
    buffer_load_dwordx4 v[40:43], v10, s[16:19], s28 offen offset:0
    buffer_load_dwordx4 v[44:47], v10, s[16:19], s28 offen offset:1024
    buffer_load_dwordx4 v[48:51], v10, s[16:19], s28 offen offset:2048
    buffer_load_dwordx4 v[52:55], v10, s[16:19], s29 offen offset:0
    buffer_load_dwordx4 v[56:59], v10, s[16:19], s29 offen offset:1024
    buffer_load_dwordx4 v[60:63], v10, s[16:19], s29 offen offset:2048
    v_xor_b32 v64, 1, v2
    v_lshlrev_b32 v64, 2, v64
    v_xor_b32 v65, 2, v2
    v_lshlrev_b32 v65, 2, v65
    v_xor_b32 v66, 4, v2
    v_lshlrev_b32 v66, 2, v66
    v_xor_b32 v67, 8, v2
    v_lshlrev_b32 v67, 2, v67
    v_xor_b32 v68, 16, v2
    v_lshlrev_b32 v68, 2, v68
    v_xor_b32 v69, 32, v2
    v_lshlrev_b32 v69, 2, v69
    s_waitcnt vmcnt(6)
    v_lshlrev_b32 v12, 16, v4
    v_and_b32 v13, 0xffff0000, v4
    v_lshlrev_b32 v14, 16, v5
    v_and_b32 v15, 0xffff0000, v5
    v_lshlrev_b32 v16, 16, v6
    v_and_b32 v17, 0xffff0000, v6
    v_lshlrev_b32 v18, 16, v7
    v_and_b32 v19, 0xffff0000, v7
    v_lshlrev_b32 v20, 16, v8
    v_and_b32 v21, 0xffff0000, v8
    v_lshlrev_b32 v22, 16, v9
    v_and_b32 v23, 0xffff0000, v9
    v_add_f32 v24, v12, v13
    v_add_f32 v24, v24, v14
    v_add_f32 v24, v24, v15
    v_add_f32 v24, v24, v16
    v_add_f32 v24, v24, v17
    v_add_f32 v24, v24, v18
    v_add_f32 v24, v24, v19
    v_add_f32 v24, v24, v20
    v_add_f32 v24, v24, v21
    v_add_f32 v24, v24, v22
    v_add_f32 v24, v24, v23
    ds_bpermute_b32 v25, v64, v24
    s_waitcnt lgkmcnt(0)
    v_add_f32 v24, v24, v25
    ds_bpermute_b32 v25, v65, v24
    s_waitcnt lgkmcnt(0)
    v_add_f32 v24, v24, v25
    ds_bpermute_b32 v25, v66, v24
    s_waitcnt lgkmcnt(0)
    v_add_f32 v24, v24, v25
    ds_bpermute_b32 v25, v67, v24
    s_waitcnt lgkmcnt(0)
    v_add_f32 v24, v24, v25
    ds_bpermute_b32 v25, v68, v24
    s_waitcnt lgkmcnt(0)
    v_add_f32 v24, v24, v25
    ds_bpermute_b32 v25, v69, v24
    s_waitcnt lgkmcnt(0)
    v_add_f32 v24, v24, v25
    v_mul_f32 v24, 0x3aaaaaab, v24
    v_sub_f32 v26, v12, v24
    v_mul_f32 v27, v26, v26
    v_sub_f32 v26, v13, v24
    v_fmac_f32 v27, v26, v26
    v_sub_f32 v26, v14, v24
    v_fmac_f32 v27, v26, v26
    v_sub_f32 v26, v15, v24
    v_fmac_f32 v27, v26, v26
    v_sub_f32 v26, v16, v24
    v_fmac_f32 v27, v26, v26
    v_sub_f32 v26, v17, v24
    v_fmac_f32 v27, v26, v26
    v_sub_f32 v26, v18, v24
    v_fmac_f32 v27, v26, v26
    v_sub_f32 v26, v19, v24
    v_fmac_f32 v27, v26, v26
    v_sub_f32 v26, v20, v24
    v_fmac_f32 v27, v26, v26
    v_sub_f32 v26, v21, v24
    v_fmac_f32 v27, v26, v26
    v_sub_f32 v26, v22, v24
    v_fmac_f32 v27, v26, v26
    v_sub_f32 v26, v23, v24
    v_fmac_f32 v27, v26, v26
    ds_bpermute_b32 v25, v64, v27
    s_waitcnt lgkmcnt(0)
    v_add_f32 v27, v27, v25
    ds_bpermute_b32 v25, v65, v27
    s_waitcnt lgkmcnt(0)
    v_add_f32 v27, v27, v25
    ds_bpermute_b32 v25, v66, v27
    s_waitcnt lgkmcnt(0)
    v_add_f32 v27, v27, v25
    ds_bpermute_b32 v25, v67, v27
    s_waitcnt lgkmcnt(0)
    v_add_f32 v27, v27, v25
    ds_bpermute_b32 v25, v68, v27
    s_waitcnt lgkmcnt(0)
    v_add_f32 v27, v27, v25
    ds_bpermute_b32 v25, v69, v27
    s_waitcnt lgkmcnt(0)
    v_add_f32 v27, v27, v25
    v_mul_f32 v27, 0x3aaaaaab, v27
    v_cvt_pk_bf16_f32 v25, v24, v27
    v_lshlrev_b32 v24, 16, v25
    v_and_b32 v27, 0xffff0000, v25
    v_add_f32 v27, 0x3727c5ac, v27
    v_mov_b32 v26, 0
    v_cvt_pk_bf16_f32 v25, v27, v26
    v_lshlrev_b32 v27, 16, v25
    v_and_b32 v26, 0xffff0000, v25
    v_sqrt_f32 v27, v27
    s_nop 0
    v_cvt_pk_bf16_f32 v25, v27, v26
    v_lshlrev_b32 v27, 16, v25
    v_and_b32 v26, 0xffff0000, v25
    v_rcp_f32 v27, v27
    v_sub_f32 v12, v12, v24
    v_sub_f32 v13, v13, v24
    v_sub_f32 v14, v14, v24
    v_sub_f32 v15, v15, v24
    v_sub_f32 v16, v16, v24
    v_sub_f32 v17, v17, v24
    v_sub_f32 v18, v18, v24
    v_sub_f32 v19, v19, v24
    v_sub_f32 v20, v20, v24
    v_sub_f32 v21, v21, v24
    v_sub_f32 v22, v22, v24
    v_sub_f32 v23, v23, v24
    v_cvt_pk_bf16_f32 v25, v12, v13
    v_lshlrev_b32 v12, 16, v25
    v_and_b32 v13, 0xffff0000, v25
    v_cvt_pk_bf16_f32 v25, v14, v15
    v_lshlrev_b32 v14, 16, v25
    v_and_b32 v15, 0xffff0000, v25
    v_cvt_pk_bf16_f32 v25, v16, v17
    v_lshlrev_b32 v16, 16, v25
    v_and_b32 v17, 0xffff0000, v25
    v_cvt_pk_bf16_f32 v25, v18, v19
    v_lshlrev_b32 v18, 16, v25
    v_and_b32 v19, 0xffff0000, v25
    v_cvt_pk_bf16_f32 v25, v20, v21
    v_lshlrev_b32 v20, 16, v25
    v_and_b32 v21, 0xffff0000, v25
    v_cvt_pk_bf16_f32 v25, v22, v23
    v_lshlrev_b32 v22, 16, v25
    v_and_b32 v23, 0xffff0000, v25
    v_mul_f32 v12, v12, v27
    v_mul_f32 v13, v13, v27
    v_mul_f32 v14, v14, v27
    v_mul_f32 v15, v15, v27
    v_mul_f32 v16, v16, v27
    v_mul_f32 v17, v17, v27
    v_mul_f32 v18, v18, v27
    v_mul_f32 v19, v19, v27
    v_mul_f32 v20, v20, v27
    v_mul_f32 v21, v21, v27
    v_mul_f32 v22, v22, v27
    v_mul_f32 v23, v23, v27
    v_cvt_pk_bf16_f32 v25, v12, v13
    v_lshlrev_b32 v12, 16, v25
    v_and_b32 v13, 0xffff0000, v25
    v_cvt_pk_bf16_f32 v25, v14, v15
    v_lshlrev_b32 v14, 16, v25
    v_and_b32 v15, 0xffff0000, v25
    v_cvt_pk_bf16_f32 v25, v16, v17
    v_lshlrev_b32 v16, 16, v25
    v_and_b32 v17, 0xffff0000, v25
    v_cvt_pk_bf16_f32 v25, v18, v19
    v_lshlrev_b32 v18, 16, v25
    v_and_b32 v19, 0xffff0000, v25
    v_cvt_pk_bf16_f32 v25, v20, v21
    v_lshlrev_b32 v20, 16, v25
    v_and_b32 v21, 0xffff0000, v25
    v_cvt_pk_bf16_f32 v25, v22, v23
    v_lshlrev_b32 v22, 16, v25
    v_and_b32 v23, 0xffff0000, v25
    s_waitcnt vmcnt(0)
    v_add_f32 v52, 1.0, v52
    v_add_f32 v53, 1.0, v53
    v_add_f32 v54, 1.0, v54
    v_add_f32 v55, 1.0, v55
    v_add_f32 v56, 1.0, v56
    v_add_f32 v57, 1.0, v57
    v_add_f32 v58, 1.0, v58
    v_add_f32 v59, 1.0, v59
    v_add_f32 v60, 1.0, v60
    v_add_f32 v61, 1.0, v61
    v_add_f32 v62, 1.0, v62
    v_add_f32 v63, 1.0, v63
    v_cvt_pk_bf16_f32 v25, v52, v53
    v_lshlrev_b32 v52, 16, v25
    v_and_b32 v53, 0xffff0000, v25
    v_cvt_pk_bf16_f32 v25, v54, v55
    v_lshlrev_b32 v54, 16, v25
    v_and_b32 v55, 0xffff0000, v25
    v_cvt_pk_bf16_f32 v25, v56, v57
    v_lshlrev_b32 v56, 16, v25
    v_and_b32 v57, 0xffff0000, v25
    v_cvt_pk_bf16_f32 v25, v58, v59
    v_lshlrev_b32 v58, 16, v25
    v_and_b32 v59, 0xffff0000, v25
    v_cvt_pk_bf16_f32 v25, v60, v61
    v_lshlrev_b32 v60, 16, v25
    v_and_b32 v61, 0xffff0000, v25
    v_cvt_pk_bf16_f32 v25, v62, v63
    v_lshlrev_b32 v62, 16, v25
    v_and_b32 v63, 0xffff0000, v25
    v_mul_f32 v12, v12, v52
    v_mul_f32 v13, v13, v53
    v_mul_f32 v14, v14, v54
    v_mul_f32 v15, v15, v55
    v_mul_f32 v16, v16, v56
    v_mul_f32 v17, v17, v57
    v_mul_f32 v18, v18, v58
    v_mul_f32 v19, v19, v59
    v_mul_f32 v20, v20, v60
    v_mul_f32 v21, v21, v61
    v_mul_f32 v22, v22, v62
    v_mul_f32 v23, v23, v63
    v_cvt_pk_bf16_f32 v25, v12, v13
    v_lshlrev_b32 v12, 16, v25
    v_and_b32 v13, 0xffff0000, v25
    v_cvt_pk_bf16_f32 v25, v14, v15
    v_lshlrev_b32 v14, 16, v25
    v_and_b32 v15, 0xffff0000, v25
    v_cvt_pk_bf16_f32 v25, v16, v17
    v_lshlrev_b32 v16, 16, v25
    v_and_b32 v17, 0xffff0000, v25
    v_cvt_pk_bf16_f32 v25, v18, v19
    v_lshlrev_b32 v18, 16, v25
    v_and_b32 v19, 0xffff0000, v25
    v_cvt_pk_bf16_f32 v25, v20, v21
    v_lshlrev_b32 v20, 16, v25
    v_and_b32 v21, 0xffff0000, v25
    v_cvt_pk_bf16_f32 v25, v22, v23
    v_lshlrev_b32 v22, 16, v25
    v_and_b32 v23, 0xffff0000, v25
    v_add_f32 v12, v12, v40
    v_add_f32 v13, v13, v41
    v_add_f32 v14, v14, v42
    v_add_f32 v15, v15, v43
    v_add_f32 v16, v16, v44
    v_add_f32 v17, v17, v45
    v_add_f32 v18, v18, v46
    v_add_f32 v19, v19, v47
    v_add_f32 v20, v20, v48
    v_add_f32 v21, v21, v49
    v_add_f32 v22, v22, v50
    v_add_f32 v23, v23, v51
    v_cvt_pk_bf16_f32 v4, v12, v13
    v_cvt_pk_bf16_f32 v5, v14, v15
    v_cvt_pk_bf16_f32 v6, v16, v17
    v_cvt_pk_bf16_f32 v7, v18, v19
    v_cvt_pk_bf16_f32 v8, v20, v21
    v_cvt_pk_bf16_f32 v9, v22, v23
    buffer_store_dwordx2 v[4:5], v3, s[20:23], s26 offen
    buffer_store_dwordx2 v[6:7], v3, s[20:23], s26 offen offset:512
    buffer_store_dwordx2 v[8:9], v3, s[20:23], s26 offen offset:1024
    s_waitcnt vmcnt(0)
L_dit_ln2_kernel_1:
    s_endpgm
.section .rodata,"a"
.p2align 6
.amdhsa_kernel dit_ln2_kernel
  .amdhsa_next_free_vgpr 72
  .amdhsa_next_free_sgpr 100
  .amdhsa_accum_offset 72
  .amdhsa_group_segment_fixed_size 0
  .amdhsa_kernarg_size 80
  .amdhsa_user_sgpr_count 2
  .amdhsa_user_sgpr_kernarg_segment_ptr 1
  .amdhsa_system_sgpr_workgroup_id_x 1
.end_amdhsa_kernel
.text
.globl dit_fc1_kernel
.p2align 8
.type dit_fc1_kernel,@function
dit_fc1_kernel:
    s_cmp_ge_u32 s2, 256
    s_cbranch_scc1 L_dit_fc1_kernel_1
    s_load_dwordx2 s[4:5], s[0:1], 72
    s_load_dwordx2 s[6:7], s[0:1], 40
    s_load_dwordx2 s[8:9], s[0:1], 72
    s_load_dwordx2 s[10:11], s[0:1], 72
    s_and_b32 s54, s2, 7
    s_mul_i32 s54, s54, 32
    s_lshr_b32 s55, s2, 3
    s_add_u32 s54, s54, s55
    s_mul_hi_u32 s30, s54, 268435457
    s_mul_i32 s31, s30, 16
    s_sub_u32 s31, s54, s31
    s_mul_hi_u32 s32, s30, 268435457
    s_mul_i32 s33, s32, 16
    s_sub_u32 s33, s30, s33
    v_lshrrev_b32 v1, 6, v0
    v_and_b32 v2, 63, v0
    s_nop 0
    v_readfirstlane_b32 s3, v1
    v_and_b32 v1, 3, v1
    s_lshr_b32 s53, s3, 2
    s_and_b32 s3, s3, 3
    s_waitcnt lgkmcnt(0)
    s_mul_i32 s34, s32, 0
    s_add_u32 s34, s34, 41943040
    s_add_u32 s12, s4, s34
    s_addc_u32 s13, s5, 0
    s_mov_b32 s14, 3145728
    s_mov_b32 s15, 0x00020000
    s_mul_i32 s34, s32, 0
    s_add_u32 s34, s34, 0
    s_add_u32 s16, s6, s34
    s_addc_u32 s17, s7, 0
    s_mov_b32 s18, 4718592
    s_mov_b32 s19, 0x00020000
    s_mul_i32 s34, s32, 0
    s_add_u32 s34, s34, 46137344
    s_add_u32 s20, s8, s34
    s_addc_u32 s21, s9, 0
    s_mov_b32 s22, 12582912
    s_mov_b32 s23, 0x00020000
    s_mov_b32 s24, s10
    s_mov_b32 s25, s11
    s_mov_b32 s26, 36864
    s_mov_b32 s27, 0x00020000
    v_lshrrev_b32 v27, 3, v2
    v_and_b32 v28, 7, v2
    v_xor_b32 v28, v28, v27
    s_mul_i32 s35, s33, 128
    s_lshl_b32 s36, s3, 3
    s_add_u32 s35, s35, s36
    v_add_u32 v29, s35, v27
    s_mov_b32 s36, 1536
    v_mul_lo_u32 v29, v29, s36
    v_lshl_add_u32 v4, v28, 4, v29
    s_mov_b32 s36, 178956971
    s_mul_i32 s35, s31, 384
    s_mov_b32 s37, 6144
    s_lshl_b32 s43, s3, 6
    v_add_u32 v29, s43, v2
    v_add_u32 v29, 0, v29
    v_mul_hi_u32 v30, v29, s36
    v_mul_u32_u24 v31, 24, v30
    v_sub_u32 v31, v29, v31
    v_bfe_u32 v33, v30, 3, 1
    v_bfe_u32 v32, v30, 1, 1
    v_lshl_or_b32 v32, v33, 1, v32
    v_lshrrev_b32 v33, 1, v31
    v_xor_b32 v33, v33, v32
    v_and_b32 v31, 1, v31
    v_lshl_or_b32 v31, v33, 1, v31
    v_mul_lo_u32 v32, v30, s37
    v_lshl_add_u32 v32, v31, 4, v32
    v_add_u32 v5, s35, v32
    s_lshl_b32 s43, s3, 6
    v_add_u32 v29, s43, v2
    v_add_u32 v29, 256, v29
    v_mul_hi_u32 v30, v29, s36
    v_mul_u32_u24 v31, 24, v30
    v_sub_u32 v31, v29, v31
    v_bfe_u32 v33, v30, 3, 1
    v_bfe_u32 v32, v30, 1, 1
    v_lshl_or_b32 v32, v33, 1, v32
    v_lshrrev_b32 v33, 1, v31
    v_xor_b32 v33, v33, v32
    v_and_b32 v31, 1, v31
    v_lshl_or_b32 v31, v33, 1, v31
    v_mul_lo_u32 v32, v30, s37
    v_lshl_add_u32 v32, v31, 4, v32
    v_add_u32 v6, s35, v32
    s_lshl_b32 s43, s3, 6
    v_add_u32 v29, s43, v2
    v_add_u32 v29, 512, v29
    v_mul_hi_u32 v30, v29, s36
    v_mul_u32_u24 v31, 24, v30
    v_sub_u32 v31, v29, v31
    v_bfe_u32 v33, v30, 3, 1
    v_bfe_u32 v32, v30, 1, 1
    v_lshl_or_b32 v32, v33, 1, v32
    v_lshrrev_b32 v33, 1, v31
    v_xor_b32 v33, v33, v32
    v_and_b32 v31, 1, v31
    v_lshl_or_b32 v31, v33, 1, v31
    v_mul_lo_u32 v32, v30, s37
    v_lshl_add_u32 v32, v31, 4, v32
    v_add_u32 v7, s35, v32
    s_lshl_b32 s43, s3, 6
    v_add_u32 v29, s43, v2
    v_add_u32 v29, 768, v29
    v_mul_hi_u32 v30, v29, s36
    v_mul_u32_u24 v31, 24, v30
    v_sub_u32 v31, v29, v31
    v_bfe_u32 v33, v30, 3, 1
    v_bfe_u32 v32, v30, 1, 1
    v_lshl_or_b32 v32, v33, 1, v32
    v_lshrrev_b32 v33, 1, v31
    v_xor_b32 v33, v33, v32
    v_and_b32 v31, 1, v31
    v_lshl_or_b32 v31, v33, 1, v31
    v_mul_lo_u32 v32, v30, s37
    v_lshl_add_u32 v32, v31, 4, v32
    v_add_u32 v8, s35, v32
    s_lshl_b32 s43, s3, 6
    v_add_u32 v29, s43, v2
    v_add_u32 v29, 1024, v29
    v_mul_hi_u32 v30, v29, s36
    v_mul_u32_u24 v31, 24, v30
    v_sub_u32 v31, v29, v31
    v_bfe_u32 v33, v30, 3, 1
    v_bfe_u32 v32, v30, 1, 1
    v_lshl_or_b32 v32, v33, 1, v32
    v_lshrrev_b32 v33, 1, v31
    v_xor_b32 v33, v33, v32
    v_and_b32 v31, 1, v31
    v_lshl_or_b32 v31, v33, 1, v31
    v_mul_lo_u32 v32, v30, s37
    v_lshl_add_u32 v32, v31, 4, v32
    v_add_u32 v9, s35, v32
    s_lshl_b32 s43, s3, 6
    v_add_u32 v29, s43, v2
    v_add_u32 v29, 1280, v29
    v_mul_hi_u32 v30, v29, s36
    v_mul_u32_u24 v31, 24, v30
    v_sub_u32 v31, v29, v31
    v_bfe_u32 v33, v30, 3, 1
    v_bfe_u32 v32, v30, 1, 1
    v_lshl_or_b32 v32, v33, 1, v32
    v_lshrrev_b32 v33, 1, v31
    v_xor_b32 v33, v33, v32
    v_and_b32 v31, 1, v31
    v_lshl_or_b32 v31, v33, 1, v31
    v_mul_lo_u32 v32, v30, s37
    v_lshl_add_u32 v32, v31, 4, v32
    v_add_u32 v10, s35, v32
    v_lshrrev_b32 v27, 1, v1
    v_and_b32 v28, 1, v1
    v_and_b32 v29, 15, v2
    v_lshrrev_b32 v30, 4, v2
    v_mul_u32_u24 v31, 64, v27
    v_add_u32 v31, v31, v29
    v_and_b32 v32, 7, v2
    v_xor_b32 v32, v32, v30
    v_lshlrev_b32 v32, 4, v32
    v_lshl_add_u32 v11, v31, 7, v32
    v_xor_b32 v12, 64, v11
    v_lshrrev_b32 v31, 2, v29
    v_lshl_add_u32 v31, v30, 3, v31
    v_bfe_u32 v33, v31, 3, 1
    v_bfe_u32 v32, v31, 1, 1
    v_lshl_or_b32 v32, v33, 1, v32
    v_mul_u32_u24 v31, 384, v31
    v_and_b32 v33, 3, v2
    v_lshl_add_u32 v31, v33, 3, v31
    v_add_u32 v31, 16384, v31
    v_mul_u32_u24 v33, 6, v28
    v_add_u32 v33, 0, v33
    v_xor_b32 v33, v33, v32
    v_lshl_add_u32 v13, v33, 5, v31
    v_mul_u32_u24 v33, 6, v28
    v_add_u32 v33, 1, v33
    v_xor_b32 v33, v33, v32
    v_lshl_add_u32 v14, v33, 5, v31
    v_mul_u32_u24 v33, 6, v28
    v_add_u32 v33, 2, v33
    v_xor_b32 v33, v33, v32
    v_lshl_add_u32 v15, v33, 5, v31
    v_mul_u32_u24 v33, 6, v28
    v_add_u32 v33, 3, v33
    v_xor_b32 v33, v33, v32
    v_lshl_add_u32 v16, v33, 5, v31
    v_mul_u32_u24 v33, 6, v28
    v_add_u32 v33, 4, v33
    v_xor_b32 v33, v33, v32
    v_lshl_add_u32 v17, v33, 5, v31
    v_mul_u32_u24 v33, 6, v28
    v_add_u32 v33, 5, v33
    v_xor_b32 v33, v33, v32
    v_lshl_add_u32 v18, v33, 5, v31
    v_mov_b32 v152, 0
    v_mov_b32 v153, 0
    v_mov_b32 v154, 0
    v_mov_b32 v155, 0
    v_mov_b32 v156, 0
    v_mov_b32 v157, 0
    v_mov_b32 v158, 0
    v_mov_b32 v159, 0
    v_mov_b32 v160, 0
    v_mov_b32 v161, 0
    v_mov_b32 v162, 0
    v_mov_b32 v163, 0
    v_mov_b32 v164, 0
    v_mov_b32 v165, 0
    v_mov_b32 v166, 0
    v_mov_b32 v167, 0
    v_mov_b32 v168, 0
    v_mov_b32 v169, 0
    v_mov_b32 v170, 0
    v_mov_b32 v171, 0
    v_mov_b32 v172, 0
    v_mov_b32 v173, 0
    v_mov_b32 v174, 0
    v_mov_b32 v175, 0
    v_mov_b32 v176, 0
    v_mov_b32 v177, 0
    v_mov_b32 v178, 0
    v_mov_b32 v179, 0
    v_mov_b32 v180, 0
    v_mov_b32 v181, 0
    v_mov_b32 v182, 0
    v_mov_b32 v183, 0
    v_mov_b32 v184, 0
    v_mov_b32 v185, 0
    v_mov_b32 v186, 0
    v_mov_b32 v187, 0
    v_mov_b32 v188, 0
    v_mov_b32 v189, 0
    v_mov_b32 v190, 0
    v_mov_b32 v191, 0
    v_mov_b32 v192, 0
    v_mov_b32 v193, 0
    v_mov_b32 v194, 0
    v_mov_b32 v195, 0
    v_mov_b32 v196, 0
    v_mov_b32 v197, 0
    v_mov_b32 v198, 0
    v_mov_b32 v199, 0
    v_mov_b32 v200, 0
    v_mov_b32 v201, 0
    v_mov_b32 v202, 0
    v_mov_b32 v203, 0
    v_mov_b32 v204, 0
    v_mov_b32 v205, 0
    v_mov_b32 v206, 0
    v_mov_b32 v207, 0
    v_mov_b32 v208, 0
    v_mov_b32 v209, 0
    v_mov_b32 v210, 0
    v_mov_b32 v211, 0
    v_mov_b32 v212, 0
    v_mov_b32 v213, 0
    v_mov_b32 v214, 0
    v_mov_b32 v215, 0
    v_mov_b32 v216, 0
    v_mov_b32 v217, 0
    v_mov_b32 v218, 0
    v_mov_b32 v219, 0
    v_mov_b32 v220, 0
    v_mov_b32 v221, 0
    v_mov_b32 v222, 0
    v_mov_b32 v223, 0
    v_mov_b32 v224, 0
    v_mov_b32 v225, 0
    v_mov_b32 v226, 0
    v_mov_b32 v227, 0
    v_mov_b32 v228, 0
    v_mov_b32 v229, 0
    v_mov_b32 v230, 0
    v_mov_b32 v231, 0
    v_mov_b32 v232, 0
    v_mov_b32 v233, 0
    v_mov_b32 v234, 0
    v_mov_b32 v235, 0
    v_mov_b32 v236, 0
    v_mov_b32 v237, 0
    v_mov_b32 v238, 0
    v_mov_b32 v239, 0
    v_mov_b32 v240, 0
    v_mov_b32 v241, 0
    v_mov_b32 v242, 0
    v_mov_b32 v243, 0
    v_mov_b32 v244, 0
    v_mov_b32 v245, 0
    v_mov_b32 v246, 0
    v_mov_b32 v247, 0
    s_mov_b32 s38, 0
    s_mov_b32 s39, 0
    s_lshl_b32 s48, s3, 10
    s_mov_b32 s49, s48
    s_mov_b32 s50, 0
    s_mov_b32 s42, 9
    s_cmp_eq_u32 s53, 0
    s_cbranch_scc1 L_dit_fc1_kernel_2
    s_add_u32 m0, s49, 0
    s_add_u32 s51, s38, 0
    buffer_load_dwordx4 v4, s[12:15], s51 offen lds
    s_add_u32 m0, s49, 4096
    s_add_u32 s51, s38, 49152
    buffer_load_dwordx4 v4, s[12:15], s51 offen lds
    s_add_u32 m0, s49, 8192
    s_add_u32 s51, s38, 98304
    buffer_load_dwordx4 v4, s[12:15], s51 offen lds
    s_add_u32 m0, s49, 12288
    s_add_u32 s51, s38, 147456
    buffer_load_dwordx4 v4, s[12:15], s51 offen lds
    s_add_u32 m0, s49, 16384
    s_nop 0
    buffer_load_dwordx4 v5, s[16:19], s39 offen lds
    s_add_u32 m0, s49, 20480
    s_nop 0
    buffer_load_dwordx4 v6, s[16:19], s39 offen lds
    s_add_u32 m0, s49, 24576
    s_nop 0
    buffer_load_dwordx4 v7, s[16:19], s39 offen lds
    s_add_u32 m0, s49, 28672
    s_nop 0
    buffer_load_dwordx4 v8, s[16:19], s39 offen lds
    s_add_u32 m0, s49, 32768
    s_nop 0
    buffer_load_dwordx4 v9, s[16:19], s39 offen lds
    s_add_u32 m0, s49, 36864
    s_nop 0
    buffer_load_dwordx4 v10, s[16:19], s39 offen lds
    s_add_u32 s38, s38, 128
    s_add_u32 s39, s39, 393216
    s_add_u32 s49, s49, 40960
    s_sub_u32 s51, s49, s48
    s_cmp_ge_u32 s51, 163840
    s_cselect_b32 s49, s48, s49
    s_add_u32 m0, s49, 0
    s_add_u32 s51, s38, 0
    buffer_load_dwordx4 v4, s[12:15], s51 offen lds
    s_add_u32 m0, s49, 4096
    s_add_u32 s51, s38, 49152
    buffer_load_dwordx4 v4, s[12:15], s51 offen lds
    s_add_u32 m0, s49, 8192
    s_add_u32 s51, s38, 98304
    buffer_load_dwordx4 v4, s[12:15], s51 offen lds
    s_add_u32 m0, s49, 12288
    s_add_u32 s51, s38, 147456
    buffer_load_dwordx4 v4, s[12:15], s51 offen lds
    s_add_u32 m0, s49, 16384
    s_nop 0
    buffer_load_dwordx4 v5, s[16:19], s39 offen lds
    s_add_u32 m0, s49, 20480
    s_nop 0
    buffer_load_dwordx4 v6, s[16:19], s39 offen lds
    s_add_u32 m0, s49, 24576
    s_nop 0
    buffer_load_dwordx4 v7, s[16:19], s39 offen lds
    s_add_u32 m0, s49, 28672
    s_nop 0
    buffer_load_dwordx4 v8, s[16:19], s39 offen lds
    s_add_u32 m0, s49, 32768
    s_nop 0
    buffer_load_dwordx4 v9, s[16:19], s39 offen lds
    s_add_u32 m0, s49, 36864
    s_nop 0
    buffer_load_dwordx4 v10, s[16:19], s39 offen lds
    s_add_u32 s38, s38, 128
    s_add_u32 s39, s39, 393216
    s_add_u32 s49, s49, 40960
    s_sub_u32 s51, s49, s48
    s_cmp_ge_u32 s51, 163840
    s_cselect_b32 s49, s48, s49
    s_add_u32 m0, s49, 0
    s_add_u32 s51, s38, 0
    buffer_load_dwordx4 v4, s[12:15], s51 offen lds
    s_add_u32 m0, s49, 4096
    s_add_u32 s51, s38, 49152
    buffer_load_dwordx4 v4, s[12:15], s51 offen lds
    s_add_u32 m0, s49, 8192
    s_add_u32 s51, s38, 98304
    buffer_load_dwordx4 v4, s[12:15], s51 offen lds
    s_add_u32 m0, s49, 12288
    s_add_u32 s51, s38, 147456
    buffer_load_dwordx4 v4, s[12:15], s51 offen lds
    s_add_u32 m0, s49, 16384
    s_nop 0
    buffer_load_dwordx4 v5, s[16:19], s39 offen lds
    s_add_u32 m0, s49, 20480
    s_nop 0
    buffer_load_dwordx4 v6, s[16:19], s39 offen lds
    s_add_u32 m0, s49, 24576
    s_nop 0
    buffer_load_dwordx4 v7, s[16:19], s39 offen lds
    s_add_u32 m0, s49, 28672
    s_nop 0
    buffer_load_dwordx4 v8, s[16:19], s39 offen lds
    s_add_u32 m0, s49, 32768
    s_nop 0
    buffer_load_dwordx4 v9, s[16:19], s39 offen lds
    s_add_u32 m0, s49, 36864
    s_nop 0
    buffer_load_dwordx4 v10, s[16:19], s39 offen lds
    s_add_u32 s38, s38, 128
    s_add_u32 s39, s39, 393216
    s_add_u32 s49, s49, 40960
    s_sub_u32 s51, s49, s48
    s_cmp_ge_u32 s51, 163840
    s_cselect_b32 s49, s48, s49
L_dit_fc1_kernel_3:
    s_waitcnt vmcnt(20)
    s_barrier
    s_add_u32 m0, s49, 0
    s_add_u32 s51, s38, 0
    buffer_load_dwordx4 v4, s[12:15], s51 offen lds
    s_add_u32 m0, s49, 4096
    s_add_u32 s51, s38, 49152
    buffer_load_dwordx4 v4, s[12:15], s51 offen lds
    s_add_u32 m0, s49, 8192
    s_add_u32 s51, s38, 98304
    buffer_load_dwordx4 v4, s[12:15], s51 offen lds
    s_add_u32 m0, s49, 12288
    s_add_u32 s51, s38, 147456
    buffer_load_dwordx4 v4, s[12:15], s51 offen lds
    s_add_u32 m0, s49, 16384
    s_nop 0
    buffer_load_dwordx4 v5, s[16:19], s39 offen lds
    s_add_u32 m0, s49, 20480
    s_nop 0
    buffer_load_dwordx4 v6, s[16:19], s39 offen lds
    s_add_u32 m0, s49, 24576
    s_nop 0
    buffer_load_dwordx4 v7, s[16:19], s39 offen lds
    s_add_u32 m0, s49, 28672
    s_nop 0
    buffer_load_dwordx4 v8, s[16:19], s39 offen lds
    s_add_u32 m0, s49, 32768
    s_nop 0
    buffer_load_dwordx4 v9, s[16:19], s39 offen lds
    s_add_u32 m0, s49, 36864
    s_nop 0
    buffer_load_dwordx4 v10, s[16:19], s39 offen lds
    s_add_u32 s38, s38, 128
    s_add_u32 s39, s39, 393216
    s_add_u32 s49, s49, 40960
    s_sub_u32 s51, s49, s48
    s_cmp_ge_u32 s51, 163840
    s_cselect_b32 s49, s48, s49
    s_sub_u32 s42, s42, 1
    s_cmp_lg_u32 s42, 0
    s_cbranch_scc1 L_dit_fc1_kernel_3
    s_waitcnt vmcnt(20)
    s_barrier
    s_waitcnt vmcnt(10)
    s_barrier
    s_waitcnt vmcnt(0)
    s_barrier
    s_barrier
    s_branch L_dit_fc1_kernel_1
L_dit_fc1_kernel_2:
    s_mov_b32 s42, 12
L_dit_fc1_kernel_4:
    s_barrier
    v_add_u32 v19, s50, v11
    v_add_u32 v20, s50, v12
    v_add_u32 v21, s50, v13
    v_add_u32 v22, s50, v14
    v_add_u32 v23, s50, v15
    v_add_u32 v24, s50, v16
    v_add_u32 v25, s50, v17
    v_add_u32 v26, s50, v18
    ds_read_b128 v[72:75], v19 offset:0
    ds_read_b128 v[76:79], v19 offset:2048
    ds_read_b128 v[80:83], v19 offset:4096
    ds_read_b128 v[84:87], v19 offset:6144
    ds_read_b64_tr_b16 v[104:105], v21 offset:0
    ds_read_b64_tr_b16 v[106:107], v21 offset:1536
    ds_read_b64_tr_b16 v[108:109], v22 offset:0
    ds_read_b64_tr_b16 v[110:111], v22 offset:1536
    ds_read_b64_tr_b16 v[112:113], v23 offset:0
    ds_read_b64_tr_b16 v[114:115], v23 offset:1536
    ds_read_b64_tr_b16 v[116:117], v24 offset:0
    ds_read_b64_tr_b16 v[118:119], v24 offset:1536
    ds_read_b64_tr_b16 v[120:121], v25 offset:0
    ds_read_b64_tr_b16 v[122:123], v25 offset:1536
    ds_read_b64_tr_b16 v[124:125], v26 offset:0
    ds_read_b64_tr_b16 v[126:127], v26 offset:1536
    ds_read_b128 v[88:91], v20 offset:0
    ds_read_b128 v[92:95], v20 offset:2048
    ds_read_b128 v[96:99], v20 offset:4096
    ds_read_b128 v[100:103], v20 offset:6144
    ds_read_b64_tr_b16 v[128:129], v21 offset:12288
    ds_read_b64_tr_b16 v[130:131], v21 offset:13824
    ds_read_b64_tr_b16 v[132:133], v22 offset:12288
    ds_read_b64_tr_b16 v[134:135], v22 offset:13824
    ds_read_b64_tr_b16 v[136:137], v23 offset:12288
    ds_read_b64_tr_b16 v[138:139], v23 offset:13824
    ds_read_b64_tr_b16 v[140:141], v24 offset:12288
    ds_read_b64_tr_b16 v[142:143], v24 offset:13824
    ds_read_b64_tr_b16 v[144:145], v25 offset:12288
    ds_read_b64_tr_b16 v[146:147], v25 offset:13824
    ds_read_b64_tr_b16 v[148:149], v26 offset:12288
    ds_read_b64_tr_b16 v[150:151], v26 offset:13824
    s_waitcnt lgkmcnt(15)
    v_mfma_f32_16x16x32_bf16 v[152:155], v[104:107], v[72:75], v[152:155]
    v_mfma_f32_16x16x32_bf16 v[156:159], v[108:111], v[72:75], v[156:159]
    v_mfma_f32_16x16x32_bf16 v[160:163], v[112:115], v[72:75], v[160:163]
    v_mfma_f32_16x16x32_bf16 v[164:167], v[116:119], v[72:75], v[164:167]
    v_mfma_f32_16x16x32_bf16 v[168:171], v[120:123], v[72:75], v[168:171]
    v_mfma_f32_16x16x32_bf16 v[172:175], v[124:127], v[72:75], v[172:175]
    v_mfma_f32_16x16x32_bf16 v[176:179], v[104:107], v[76:79], v[176:179]
    v_mfma_f32_16x16x32_bf16 v[180:183], v[108:111], v[76:79], v[180:183]
    v_mfma_f32_16x16x32_bf16 v[184:187], v[112:115], v[76:79], v[184:187]
    v_mfma_f32_16x16x32_bf16 v[188:191], v[116:119], v[76:79], v[188:191]
    v_mfma_f32_16x16x32_bf16 v[192:195], v[120:123], v[76:79], v[192:195]
    v_mfma_f32_16x16x32_bf16 v[196:199], v[124:127], v[76:79], v[196:199]
    v_mfma_f32_16x16x32_bf16 v[200:203], v[104:107], v[80:83], v[200:203]
    v_mfma_f32_16x16x32_bf16 v[204:207], v[108:111], v[80:83], v[204:207]
    v_mfma_f32_16x16x32_bf16 v[208:211], v[112:115], v[80:83], v[208:211]
    v_mfma_f32_16x16x32_bf16 v[212:215], v[116:119], v[80:83], v[212:215]
    v_mfma_f32_16x16x32_bf16 v[216:219], v[120:123], v[80:83], v[216:219]
    v_mfma_f32_16x16x32_bf16 v[220:223], v[124:127], v[80:83], v[220:223]
    v_mfma_f32_16x16x32_bf16 v[224:227], v[104:107], v[84:87], v[224:227]
    v_mfma_f32_16x16x32_bf16 v[228:231], v[108:111], v[84:87], v[228:231]
    v_mfma_f32_16x16x32_bf16 v[232:235], v[112:115], v[84:87], v[232:235]
    v_mfma_f32_16x16x32_bf16 v[236:239], v[116:119], v[84:87], v[236:239]
    v_mfma_f32_16x16x32_bf16 v[240:243], v[120:123], v[84:87], v[240:243]
    v_mfma_f32_16x16x32_bf16 v[244:247], v[124:127], v[84:87], v[244:247]
    s_waitcnt lgkmcnt(0)
    v_mfma_f32_16x16x32_bf16 v[152:155], v[128:131], v[88:91], v[152:155]
    v_mfma_f32_16x16x32_bf16 v[156:159], v[132:135], v[88:91], v[156:159]
    v_mfma_f32_16x16x32_bf16 v[160:163], v[136:139], v[88:91], v[160:163]
    v_mfma_f32_16x16x32_bf16 v[164:167], v[140:143], v[88:91], v[164:167]
    v_mfma_f32_16x16x32_bf16 v[168:171], v[144:147], v[88:91], v[168:171]
    v_mfma_f32_16x16x32_bf16 v[172:175], v[148:151], v[88:91], v[172:175]
    v_mfma_f32_16x16x32_bf16 v[176:179], v[128:131], v[92:95], v[176:179]
    v_mfma_f32_16x16x32_bf16 v[180:183], v[132:135], v[92:95], v[180:183]
    v_mfma_f32_16x16x32_bf16 v[184:187], v[136:139], v[92:95], v[184:187]
    v_mfma_f32_16x16x32_bf16 v[188:191], v[140:143], v[92:95], v[188:191]
    v_mfma_f32_16x16x32_bf16 v[192:195], v[144:147], v[92:95], v[192:195]
    v_mfma_f32_16x16x32_bf16 v[196:199], v[148:151], v[92:95], v[196:199]
    v_mfma_f32_16x16x32_bf16 v[200:203], v[128:131], v[96:99], v[200:203]
    v_mfma_f32_16x16x32_bf16 v[204:207], v[132:135], v[96:99], v[204:207]
    v_mfma_f32_16x16x32_bf16 v[208:211], v[136:139], v[96:99], v[208:211]
    v_mfma_f32_16x16x32_bf16 v[212:215], v[140:143], v[96:99], v[212:215]
    v_mfma_f32_16x16x32_bf16 v[216:219], v[144:147], v[96:99], v[216:219]
    v_mfma_f32_16x16x32_bf16 v[220:223], v[148:151], v[96:99], v[220:223]
    v_mfma_f32_16x16x32_bf16 v[224:227], v[128:131], v[100:103], v[224:227]
    v_mfma_f32_16x16x32_bf16 v[228:231], v[132:135], v[100:103], v[228:231]
    v_mfma_f32_16x16x32_bf16 v[232:235], v[136:139], v[100:103], v[232:235]
    v_mfma_f32_16x16x32_bf16 v[236:239], v[140:143], v[100:103], v[236:239]
    v_mfma_f32_16x16x32_bf16 v[240:243], v[144:147], v[100:103], v[240:243]
    v_mfma_f32_16x16x32_bf16 v[244:247], v[148:151], v[100:103], v[244:247]
    s_add_u32 s50, s50, 40960
    s_cmp_ge_u32 s50, 163840
    s_cselect_b32 s50, 0, s50
    s_sub_u32 s42, s42, 1
    s_cmp_lg_u32 s42, 0
    s_cbranch_scc1 L_dit_fc1_kernel_4
    s_mul_i32 s35, s33, 128
    v_mul_u32_u24 v32, 64, v27
    v_add3_u32 v32, v32, v29, s35
    s_mul_i32 s36, s31, 192
    v_mul_u32_u24 v33, 96, v28
    v_lshl_add_u32 v33, v30, 2, v33
    v_add_u32 v33, s36, v33
    s_mov_b32 s37, 6144
    v_mul_lo_u32 v31, v32, s37
    v_lshl_add_u32 v31, v33, 1, v31
    s_barrier
    s_mul_i32 s52, s3, 13312
    v_mul_u32_u24 v71, 208, v29
    v_lshl_add_u32 v71, v30, 3, v71
    v_add_u32 v71, s52, v71
    s_nop 7
    s_nop 7
    v_cvt_pk_bf16_f32 v32, v152, v153
    v_lshlrev_b32 v152, 16, v32
    v_and_b32 v153, 0xffff0000, v32
    v_cvt_pk_bf16_f32 v32, v154, v155
    v_lshlrev_b32 v154, 16, v32
    v_and_b32 v155, 0xffff0000, v32
    v_mul_f32 v58, v152, v152
    v_mul_f32 v58, 0x3d372713, v58
    v_add_f32 v58, 1.0, v58
    v_mul_f32 v58, v58, v152
    v_mul_f32 v58, 0xc0135761, v58
    v_mul_f32 v59, v153, v153
    v_mul_f32 v59, 0x3d372713, v59
    v_add_f32 v59, 1.0, v59
    v_mul_f32 v59, v59, v153
    v_mul_f32 v59, 0xc0135761, v59
    v_mul_f32 v60, v154, v154
    v_mul_f32 v60, 0x3d372713, v60
    v_add_f32 v60, 1.0, v60
    v_mul_f32 v60, v60, v154
    v_mul_f32 v60, 0xc0135761, v60
    v_mul_f32 v61, v155, v155
    v_mul_f32 v61, 0x3d372713, v61
    v_add_f32 v61, 1.0, v61
    v_mul_f32 v61, v61, v155
    v_mul_f32 v61, 0xc0135761, v61
    v_exp_f32 v58, v58
    v_exp_f32 v59, v59
    v_exp_f32 v60, v60
    v_exp_f32 v61, v61
    s_nop 0
    v_add_f32 v58, 1.0, v58
    v_add_f32 v59, 1.0, v59
    v_add_f32 v60, 1.0, v60
    v_add_f32 v61, 1.0, v61
    v_rcp_f32 v58, v58
    v_rcp_f32 v59, v59
    v_rcp_f32 v60, v60
    v_rcp_f32 v61, v61
    s_nop 0
    v_mul_f32 v152, v152, v58
    v_mul_f32 v153, v153, v59
    v_mul_f32 v154, v154, v60
    v_mul_f32 v155, v155, v61
    v_cvt_pk_bf16_f32 v152, v152, v153
    v_cvt_pk_bf16_f32 v153, v154, v155
    ds_write_b64 v71, v[152:153] offset:0
    v_cvt_pk_bf16_f32 v32, v156, v157
    v_lshlrev_b32 v156, 16, v32
    v_and_b32 v157, 0xffff0000, v32
    v_cvt_pk_bf16_f32 v32, v158, v159
    v_lshlrev_b32 v158, 16, v32
    v_and_b32 v159, 0xffff0000, v32
    v_mul_f32 v58, v156, v156
    v_mul_f32 v58, 0x3d372713, v58
    v_add_f32 v58, 1.0, v58
    v_mul_f32 v58, v58, v156
    v_mul_f32 v58, 0xc0135761, v58
    v_mul_f32 v59, v157, v157
    v_mul_f32 v59, 0x3d372713, v59
    v_add_f32 v59, 1.0, v59
    v_mul_f32 v59, v59, v157
    v_mul_f32 v59, 0xc0135761, v59
    v_mul_f32 v60, v158, v158
    v_mul_f32 v60, 0x3d372713, v60
    v_add_f32 v60, 1.0, v60
    v_mul_f32 v60, v60, v158
    v_mul_f32 v60, 0xc0135761, v60
    v_mul_f32 v61, v159, v159
    v_mul_f32 v61, 0x3d372713, v61
    v_add_f32 v61, 1.0, v61
    v_mul_f32 v61, v61, v159
    v_mul_f32 v61, 0xc0135761, v61
    v_exp_f32 v58, v58
    v_exp_f32 v59, v59
    v_exp_f32 v60, v60
    v_exp_f32 v61, v61
    s_nop 0
    v_add_f32 v58, 1.0, v58
    v_add_f32 v59, 1.0, v59
    v_add_f32 v60, 1.0, v60
    v_add_f32 v61, 1.0, v61
    v_rcp_f32 v58, v58
    v_rcp_f32 v59, v59
    v_rcp_f32 v60, v60
    v_rcp_f32 v61, v61
    s_nop 0
    v_mul_f32 v156, v156, v58
    v_mul_f32 v157, v157, v59
    v_mul_f32 v158, v158, v60
    v_mul_f32 v159, v159, v61
    v_cvt_pk_bf16_f32 v156, v156, v157
    v_cvt_pk_bf16_f32 v157, v158, v159
    ds_write_b64 v71, v[156:157] offset:32
    v_cvt_pk_bf16_f32 v32, v160, v161
    v_lshlrev_b32 v160, 16, v32
    v_and_b32 v161, 0xffff0000, v32
    v_cvt_pk_bf16_f32 v32, v162, v163
    v_lshlrev_b32 v162, 16, v32
    v_and_b32 v163, 0xffff0000, v32
    v_mul_f32 v58, v160, v160
    v_mul_f32 v58, 0x3d372713, v58
    v_add_f32 v58, 1.0, v58
    v_mul_f32 v58, v58, v160
    v_mul_f32 v58, 0xc0135761, v58
    v_mul_f32 v59, v161, v161
    v_mul_f32 v59, 0x3d372713, v59
    v_add_f32 v59, 1.0, v59
    v_mul_f32 v59, v59, v161
    v_mul_f32 v59, 0xc0135761, v59
    v_mul_f32 v60, v162, v162
    v_mul_f32 v60, 0x3d372713, v60
    v_add_f32 v60, 1.0, v60
    v_mul_f32 v60, v60, v162
    v_mul_f32 v60, 0xc0135761, v60
    v_mul_f32 v61, v163, v163
    v_mul_f32 v61, 0x3d372713, v61
    v_add_f32 v61, 1.0, v61
    v_mul_f32 v61, v61, v163
    v_mul_f32 v61, 0xc0135761, v61
    v_exp_f32 v58, v58
    v_exp_f32 v59, v59
    v_exp_f32 v60, v60
    v_exp_f32 v61, v61
    s_nop 0
    v_add_f32 v58, 1.0, v58
    v_add_f32 v59, 1.0, v59
    v_add_f32 v60, 1.0, v60
    v_add_f32 v61, 1.0, v61
    v_rcp_f32 v58, v58
    v_rcp_f32 v59, v59
    v_rcp_f32 v60, v60
    v_rcp_f32 v61, v61
    s_nop 0
    v_mul_f32 v160, v160, v58
    v_mul_f32 v161, v161, v59
    v_mul_f32 v162, v162, v60
    v_mul_f32 v163, v163, v61
    v_cvt_pk_bf16_f32 v160, v160, v161
    v_cvt_pk_bf16_f32 v161, v162, v163
    ds_write_b64 v71, v[160:161] offset:64
    v_cvt_pk_bf16_f32 v32, v164, v165
    v_lshlrev_b32 v164, 16, v32
    v_and_b32 v165, 0xffff0000, v32
    v_cvt_pk_bf16_f32 v32, v166, v167
    v_lshlrev_b32 v166, 16, v32
    v_and_b32 v167, 0xffff0000, v32
    v_mul_f32 v58, v164, v164
    v_mul_f32 v58, 0x3d372713, v58
    v_add_f32 v58, 1.0, v58
    v_mul_f32 v58, v58, v164
    v_mul_f32 v58, 0xc0135761, v58
    v_mul_f32 v59, v165, v165
    v_mul_f32 v59, 0x3d372713, v59
    v_add_f32 v59, 1.0, v59
    v_mul_f32 v59, v59, v165
    v_mul_f32 v59, 0xc0135761, v59
    v_mul_f32 v60, v166, v166
    v_mul_f32 v60, 0x3d372713, v60
    v_add_f32 v60, 1.0, v60
    v_mul_f32 v60, v60, v166
    v_mul_f32 v60, 0xc0135761, v60
    v_mul_f32 v61, v167, v167
    v_mul_f32 v61, 0x3d372713, v61
    v_add_f32 v61, 1.0, v61
    v_mul_f32 v61, v61, v167
    v_mul_f32 v61, 0xc0135761, v61
    v_exp_f32 v58, v58
    v_exp_f32 v59, v59
    v_exp_f32 v60, v60
    v_exp_f32 v61, v61
    s_nop 0
    v_add_f32 v58, 1.0, v58
    v_add_f32 v59, 1.0, v59
    v_add_f32 v60, 1.0, v60
    v_add_f32 v61, 1.0, v61
    v_rcp_f32 v58, v58
    v_rcp_f32 v59, v59
    v_rcp_f32 v60, v60
    v_rcp_f32 v61, v61
    s_nop 0
    v_mul_f32 v164, v164, v58
    v_mul_f32 v165, v165, v59
    v_mul_f32 v166, v166, v60
    v_mul_f32 v167, v167, v61
    v_cvt_pk_bf16_f32 v164, v164, v165
    v_cvt_pk_bf16_f32 v165, v166, v167
    ds_write_b64 v71, v[164:165] offset:96
    v_cvt_pk_bf16_f32 v32, v168, v169
    v_lshlrev_b32 v168, 16, v32
    v_and_b32 v169, 0xffff0000, v32
    v_cvt_pk_bf16_f32 v32, v170, v171
    v_lshlrev_b32 v170, 16, v32
    v_and_b32 v171, 0xffff0000, v32
    v_mul_f32 v58, v168, v168
    v_mul_f32 v58, 0x3d372713, v58
    v_add_f32 v58, 1.0, v58
    v_mul_f32 v58, v58, v168
    v_mul_f32 v58, 0xc0135761, v58
    v_mul_f32 v59, v169, v169
    v_mul_f32 v59, 0x3d372713, v59
    v_add_f32 v59, 1.0, v59
    v_mul_f32 v59, v59, v169
    v_mul_f32 v59, 0xc0135761, v59
    v_mul_f32 v60, v170, v170
    v_mul_f32 v60, 0x3d372713, v60
    v_add_f32 v60, 1.0, v60
    v_mul_f32 v60, v60, v170
    v_mul_f32 v60, 0xc0135761, v60
    v_mul_f32 v61, v171, v171
    v_mul_f32 v61, 0x3d372713, v61
    v_add_f32 v61, 1.0, v61
    v_mul_f32 v61, v61, v171
    v_mul_f32 v61, 0xc0135761, v61
    v_exp_f32 v58, v58
    v_exp_f32 v59, v59
    v_exp_f32 v60, v60
    v_exp_f32 v61, v61
    s_nop 0
    v_add_f32 v58, 1.0, v58
    v_add_f32 v59, 1.0, v59
    v_add_f32 v60, 1.0, v60
    v_add_f32 v61, 1.0, v61
    v_rcp_f32 v58, v58
    v_rcp_f32 v59, v59
    v_rcp_f32 v60, v60
    v_rcp_f32 v61, v61
    s_nop 0
    v_mul_f32 v168, v168, v58
    v_mul_f32 v169, v169, v59
    v_mul_f32 v170, v170, v60
    v_mul_f32 v171, v171, v61
    v_cvt_pk_bf16_f32 v168, v168, v169
    v_cvt_pk_bf16_f32 v169, v170, v171
    ds_write_b64 v71, v[168:169] offset:128
    v_cvt_pk_bf16_f32 v32, v172, v173
    v_lshlrev_b32 v172, 16, v32
    v_and_b32 v173, 0xffff0000, v32
    v_cvt_pk_bf16_f32 v32, v174, v175
    v_lshlrev_b32 v174, 16, v32
    v_and_b32 v175, 0xffff0000, v32
    v_mul_f32 v58, v172, v172
    v_mul_f32 v58, 0x3d372713, v58
    v_add_f32 v58, 1.0, v58
    v_mul_f32 v58, v58, v172
    v_mul_f32 v58, 0xc0135761, v58
    v_mul_f32 v59, v173, v173
    v_mul_f32 v59, 0x3d372713, v59
    v_add_f32 v59, 1.0, v59
    v_mul_f32 v59, v59, v173
    v_mul_f32 v59, 0xc0135761, v59
    v_mul_f32 v60, v174, v174
    v_mul_f32 v60, 0x3d372713, v60
    v_add_f32 v60, 1.0, v60
    v_mul_f32 v60, v60, v174
    v_mul_f32 v60, 0xc0135761, v60
    v_mul_f32 v61, v175, v175
    v_mul_f32 v61, 0x3d372713, v61
    v_add_f32 v61, 1.0, v61
    v_mul_f32 v61, v61, v175
    v_mul_f32 v61, 0xc0135761, v61
    v_exp_f32 v58, v58
    v_exp_f32 v59, v59
    v_exp_f32 v60, v60
    v_exp_f32 v61, v61
    s_nop 0
    v_add_f32 v58, 1.0, v58
    v_add_f32 v59, 1.0, v59
    v_add_f32 v60, 1.0, v60
    v_add_f32 v61, 1.0, v61
    v_rcp_f32 v58, v58
    v_rcp_f32 v59, v59
    v_rcp_f32 v60, v60
    v_rcp_f32 v61, v61
    s_nop 0
    v_mul_f32 v172, v172, v58
    v_mul_f32 v173, v173, v59
    v_mul_f32 v174, v174, v60
    v_mul_f32 v175, v175, v61
    v_cvt_pk_bf16_f32 v172, v172, v173
    v_cvt_pk_bf16_f32 v173, v174, v175
    ds_write_b64 v71, v[172:173] offset:160
    v_cvt_pk_bf16_f32 v32, v176, v177
    v_lshlrev_b32 v176, 16, v32
    v_and_b32 v177, 0xffff0000, v32
    v_cvt_pk_bf16_f32 v32, v178, v179
    v_lshlrev_b32 v178, 16, v32
    v_and_b32 v179, 0xffff0000, v32
    v_mul_f32 v58, v176, v176
    v_mul_f32 v58, 0x3d372713, v58
    v_add_f32 v58, 1.0, v58
    v_mul_f32 v58, v58, v176
    v_mul_f32 v58, 0xc0135761, v58
    v_mul_f32 v59, v177, v177
    v_mul_f32 v59, 0x3d372713, v59
    v_add_f32 v59, 1.0, v59
    v_mul_f32 v59, v59, v177
    v_mul_f32 v59, 0xc0135761, v59
    v_mul_f32 v60, v178, v178
    v_mul_f32 v60, 0x3d372713, v60
    v_add_f32 v60, 1.0, v60
    v_mul_f32 v60, v60, v178
    v_mul_f32 v60, 0xc0135761, v60
    v_mul_f32 v61, v179, v179
    v_mul_f32 v61, 0x3d372713, v61
    v_add_f32 v61, 1.0, v61
    v_mul_f32 v61, v61, v179
    v_mul_f32 v61, 0xc0135761, v61
    v_exp_f32 v58, v58
    v_exp_f32 v59, v59
    v_exp_f32 v60, v60
    v_exp_f32 v61, v61
    s_nop 0
    v_add_f32 v58, 1.0, v58
    v_add_f32 v59, 1.0, v59
    v_add_f32 v60, 1.0, v60
    v_add_f32 v61, 1.0, v61
    v_rcp_f32 v58, v58
    v_rcp_f32 v59, v59
    v_rcp_f32 v60, v60
    v_rcp_f32 v61, v61
    s_nop 0
    v_mul_f32 v176, v176, v58
    v_mul_f32 v177, v177, v59
    v_mul_f32 v178, v178, v60
    v_mul_f32 v179, v179, v61
    v_cvt_pk_bf16_f32 v176, v176, v177
    v_cvt_pk_bf16_f32 v177, v178, v179
    ds_write_b64 v71, v[176:177] offset:3328
    v_cvt_pk_bf16_f32 v32, v180, v181
    v_lshlrev_b32 v180, 16, v32
    v_and_b32 v181, 0xffff0000, v32
    v_cvt_pk_bf16_f32 v32, v182, v183
    v_lshlrev_b32 v182, 16, v32
    v_and_b32 v183, 0xffff0000, v32
    v_mul_f32 v58, v180, v180
    v_mul_f32 v58, 0x3d372713, v58
    v_add_f32 v58, 1.0, v58
    v_mul_f32 v58, v58, v180
    v_mul_f32 v58, 0xc0135761, v58
    v_mul_f32 v59, v181, v181
    v_mul_f32 v59, 0x3d372713, v59
    v_add_f32 v59, 1.0, v59
    v_mul_f32 v59, v59, v181
    v_mul_f32 v59, 0xc0135761, v59
    v_mul_f32 v60, v182, v182
    v_mul_f32 v60, 0x3d372713, v60
    v_add_f32 v60, 1.0, v60
    v_mul_f32 v60, v60, v182
    v_mul_f32 v60, 0xc0135761, v60
    v_mul_f32 v61, v183, v183
    v_mul_f32 v61, 0x3d372713, v61
    v_add_f32 v61, 1.0, v61
    v_mul_f32 v61, v61, v183
    v_mul_f32 v61, 0xc0135761, v61
    v_exp_f32 v58, v58
    v_exp_f32 v59, v59
    v_exp_f32 v60, v60
    v_exp_f32 v61, v61
    s_nop 0
    v_add_f32 v58, 1.0, v58
    v_add_f32 v59, 1.0, v59
    v_add_f32 v60, 1.0, v60
    v_add_f32 v61, 1.0, v61
    v_rcp_f32 v58, v58
    v_rcp_f32 v59, v59
    v_rcp_f32 v60, v60
    v_rcp_f32 v61, v61
    s_nop 0
    v_mul_f32 v180, v180, v58
    v_mul_f32 v181, v181, v59
    v_mul_f32 v182, v182, v60
    v_mul_f32 v183, v183, v61
    v_cvt_pk_bf16_f32 v180, v180, v181
    v_cvt_pk_bf16_f32 v181, v182, v183
    ds_write_b64 v71, v[180:181] offset:3360
    v_cvt_pk_bf16_f32 v32, v184, v185
    v_lshlrev_b32 v184, 16, v32
    v_and_b32 v185, 0xffff0000, v32
    v_cvt_pk_bf16_f32 v32, v186, v187
    v_lshlrev_b32 v186, 16, v32
    v_and_b32 v187, 0xffff0000, v32
    v_mul_f32 v58, v184, v184
    v_mul_f32 v58, 0x3d372713, v58
    v_add_f32 v58, 1.0, v58
    v_mul_f32 v58, v58, v184
    v_mul_f32 v58, 0xc0135761, v58
    v_mul_f32 v59, v185, v185
    v_mul_f32 v59, 0x3d372713, v59
    v_add_f32 v59, 1.0, v59
    v_mul_f32 v59, v59, v185
    v_mul_f32 v59, 0xc0135761, v59
    v_mul_f32 v60, v186, v186
    v_mul_f32 v60, 0x3d372713, v60
    v_add_f32 v60, 1.0, v60
    v_mul_f32 v60, v60, v186
    v_mul_f32 v60, 0xc0135761, v60
    v_mul_f32 v61, v187, v187
    v_mul_f32 v61, 0x3d372713, v61
    v_add_f32 v61, 1.0, v61
    v_mul_f32 v61, v61, v187
    v_mul_f32 v61, 0xc0135761, v61
    v_exp_f32 v58, v58
    v_exp_f32 v59, v59
    v_exp_f32 v60, v60
    v_exp_f32 v61, v61
    s_nop 0
    v_add_f32 v58, 1.0, v58
    v_add_f32 v59, 1.0, v59
    v_add_f32 v60, 1.0, v60
    v_add_f32 v61, 1.0, v61
    v_rcp_f32 v58, v58
    v_rcp_f32 v59, v59
    v_rcp_f32 v60, v60
    v_rcp_f32 v61, v61
    s_nop 0
    v_mul_f32 v184, v184, v58
    v_mul_f32 v185, v185, v59
    v_mul_f32 v186, v186, v60
    v_mul_f32 v187, v187, v61
    v_cvt_pk_bf16_f32 v184, v184, v185
    v_cvt_pk_bf16_f32 v185, v186, v187
    ds_write_b64 v71, v[184:185] offset:3392
    v_cvt_pk_bf16_f32 v32, v188, v189
    v_lshlrev_b32 v188, 16, v32
    v_and_b32 v189, 0xffff0000, v32
    v_cvt_pk_bf16_f32 v32, v190, v191
    v_lshlrev_b32 v190, 16, v32
    v_and_b32 v191, 0xffff0000, v32
    v_mul_f32 v58, v188, v188
    v_mul_f32 v58, 0x3d372713, v58
    v_add_f32 v58, 1.0, v58
    v_mul_f32 v58, v58, v188
    v_mul_f32 v58, 0xc0135761, v58
    v_mul_f32 v59, v189, v189
    v_mul_f32 v59, 0x3d372713, v59
    v_add_f32 v59, 1.0, v59
    v_mul_f32 v59, v59, v189
    v_mul_f32 v59, 0xc0135761, v59
    v_mul_f32 v60, v190, v190
    v_mul_f32 v60, 0x3d372713, v60
    v_add_f32 v60, 1.0, v60
    v_mul_f32 v60, v60, v190
    v_mul_f32 v60, 0xc0135761, v60
    v_mul_f32 v61, v191, v191
    v_mul_f32 v61, 0x3d372713, v61
    v_add_f32 v61, 1.0, v61
    v_mul_f32 v61, v61, v191
    v_mul_f32 v61, 0xc0135761, v61
    v_exp_f32 v58, v58
    v_exp_f32 v59, v59
    v_exp_f32 v60, v60
    v_exp_f32 v61, v61
    s_nop 0
    v_add_f32 v58, 1.0, v58
    v_add_f32 v59, 1.0, v59
    v_add_f32 v60, 1.0, v60
    v_add_f32 v61, 1.0, v61
    v_rcp_f32 v58, v58
    v_rcp_f32 v59, v59
    v_rcp_f32 v60, v60
    v_rcp_f32 v61, v61
    s_nop 0
    v_mul_f32 v188, v188, v58
    v_mul_f32 v189, v189, v59
    v_mul_f32 v190, v190, v60
    v_mul_f32 v191, v191, v61
    v_cvt_pk_bf16_f32 v188, v188, v189
    v_cvt_pk_bf16_f32 v189, v190, v191
    ds_write_b64 v71, v[188:189] offset:3424
    v_cvt_pk_bf16_f32 v32, v192, v193
    v_lshlrev_b32 v192, 16, v32
    v_and_b32 v193, 0xffff0000, v32
    v_cvt_pk_bf16_f32 v32, v194, v195
    v_lshlrev_b32 v194, 16, v32
    v_and_b32 v195, 0xffff0000, v32
    v_mul_f32 v58, v192, v192
    v_mul_f32 v58, 0x3d372713, v58
    v_add_f32 v58, 1.0, v58
    v_mul_f32 v58, v58, v192
    v_mul_f32 v58, 0xc0135761, v58
    v_mul_f32 v59, v193, v193
    v_mul_f32 v59, 0x3d372713, v59
    v_add_f32 v59, 1.0, v59
    v_mul_f32 v59, v59, v193
    v_mul_f32 v59, 0xc0135761, v59
    v_mul_f32 v60, v194, v194
    v_mul_f32 v60, 0x3d372713, v60
    v_add_f32 v60, 1.0, v60
    v_mul_f32 v60, v60, v194
    v_mul_f32 v60, 0xc0135761, v60
    v_mul_f32 v61, v195, v195
    v_mul_f32 v61, 0x3d372713, v61
    v_add_f32 v61, 1.0, v61
    v_mul_f32 v61, v61, v195
    v_mul_f32 v61, 0xc0135761, v61
    v_exp_f32 v58, v58
    v_exp_f32 v59, v59
    v_exp_f32 v60, v60
    v_exp_f32 v61, v61
    s_nop 0
    v_add_f32 v58, 1.0, v58
    v_add_f32 v59, 1.0, v59
    v_add_f32 v60, 1.0, v60
    v_add_f32 v61, 1.0, v61
    v_rcp_f32 v58, v58
    v_rcp_f32 v59, v59
    v_rcp_f32 v60, v60
    v_rcp_f32 v61, v61
    s_nop 0
    v_mul_f32 v192, v192, v58
    v_mul_f32 v193, v193, v59
    v_mul_f32 v194, v194, v60
    v_mul_f32 v195, v195, v61
    v_cvt_pk_bf16_f32 v192, v192, v193
    v_cvt_pk_bf16_f32 v193, v194, v195
    ds_write_b64 v71, v[192:193] offset:3456
    v_cvt_pk_bf16_f32 v32, v196, v197
    v_lshlrev_b32 v196, 16, v32
    v_and_b32 v197, 0xffff0000, v32
    v_cvt_pk_bf16_f32 v32, v198, v199
    v_lshlrev_b32 v198, 16, v32
    v_and_b32 v199, 0xffff0000, v32
    v_mul_f32 v58, v196, v196
    v_mul_f32 v58, 0x3d372713, v58
    v_add_f32 v58, 1.0, v58
    v_mul_f32 v58, v58, v196
    v_mul_f32 v58, 0xc0135761, v58
    v_mul_f32 v59, v197, v197
    v_mul_f32 v59, 0x3d372713, v59
    v_add_f32 v59, 1.0, v59
    v_mul_f32 v59, v59, v197
    v_mul_f32 v59, 0xc0135761, v59
    v_mul_f32 v60, v198, v198
    v_mul_f32 v60, 0x3d372713, v60
    v_add_f32 v60, 1.0, v60
    v_mul_f32 v60, v60, v198
    v_mul_f32 v60, 0xc0135761, v60
    v_mul_f32 v61, v199, v199
    v_mul_f32 v61, 0x3d372713, v61
    v_add_f32 v61, 1.0, v61
    v_mul_f32 v61, v61, v199
    v_mul_f32 v61, 0xc0135761, v61
    v_exp_f32 v58, v58
    v_exp_f32 v59, v59
    v_exp_f32 v60, v60
    v_exp_f32 v61, v61
    s_nop 0
    v_add_f32 v58, 1.0, v58
    v_add_f32 v59, 1.0, v59
    v_add_f32 v60, 1.0, v60
    v_add_f32 v61, 1.0, v61
    v_rcp_f32 v58, v58
    v_rcp_f32 v59, v59
    v_rcp_f32 v60, v60
    v_rcp_f32 v61, v61
    s_nop 0
    v_mul_f32 v196, v196, v58
    v_mul_f32 v197, v197, v59
    v_mul_f32 v198, v198, v60
    v_mul_f32 v199, v199, v61
    v_cvt_pk_bf16_f32 v196, v196, v197
    v_cvt_pk_bf16_f32 v197, v198, v199
    ds_write_b64 v71, v[196:197] offset:3488
    v_cvt_pk_bf16_f32 v32, v200, v201
    v_lshlrev_b32 v200, 16, v32
    v_and_b32 v201, 0xffff0000, v32
    v_cvt_pk_bf16_f32 v32, v202, v203
    v_lshlrev_b32 v202, 16, v32
    v_and_b32 v203, 0xffff0000, v32
    v_mul_f32 v58, v200, v200
    v_mul_f32 v58, 0x3d372713, v58
    v_add_f32 v58, 1.0, v58
    v_mul_f32 v58, v58, v200
    v_mul_f32 v58, 0xc0135761, v58
    v_mul_f32 v59, v201, v201
    v_mul_f32 v59, 0x3d372713, v59
    v_add_f32 v59, 1.0, v59
    v_mul_f32 v59, v59, v201
    v_mul_f32 v59, 0xc0135761, v59
    v_mul_f32 v60, v202, v202
    v_mul_f32 v60, 0x3d372713, v60
    v_add_f32 v60, 1.0, v60
    v_mul_f32 v60, v60, v202
    v_mul_f32 v60, 0xc0135761, v60
    v_mul_f32 v61, v203, v203
    v_mul_f32 v61, 0x3d372713, v61
    v_add_f32 v61, 1.0, v61
    v_mul_f32 v61, v61, v203
    v_mul_f32 v61, 0xc0135761, v61
    v_exp_f32 v58, v58
    v_exp_f32 v59, v59
    v_exp_f32 v60, v60
    v_exp_f32 v61, v61
    s_nop 0
    v_add_f32 v58, 1.0, v58
    v_add_f32 v59, 1.0, v59
    v_add_f32 v60, 1.0, v60
    v_add_f32 v61, 1.0, v61
    v_rcp_f32 v58, v58
    v_rcp_f32 v59, v59
    v_rcp_f32 v60, v60
    v_rcp_f32 v61, v61
    s_nop 0
    v_mul_f32 v200, v200, v58
    v_mul_f32 v201, v201, v59
    v_mul_f32 v202, v202, v60
    v_mul_f32 v203, v203, v61
    v_cvt_pk_bf16_f32 v200, v200, v201
    v_cvt_pk_bf16_f32 v201, v202, v203
    ds_write_b64 v71, v[200:201] offset:6656
    v_cvt_pk_bf16_f32 v32, v204, v205
    v_lshlrev_b32 v204, 16, v32
    v_and_b32 v205, 0xffff0000, v32
    v_cvt_pk_bf16_f32 v32, v206, v207
    v_lshlrev_b32 v206, 16, v32
    v_and_b32 v207, 0xffff0000, v32
    v_mul_f32 v58, v204, v204
    v_mul_f32 v58, 0x3d372713, v58
    v_add_f32 v58, 1.0, v58
    v_mul_f32 v58, v58, v204
    v_mul_f32 v58, 0xc0135761, v58
    v_mul_f32 v59, v205, v205
    v_mul_f32 v59, 0x3d372713, v59
    v_add_f32 v59, 1.0, v59
    v_mul_f32 v59, v59, v205
    v_mul_f32 v59, 0xc0135761, v59
    v_mul_f32 v60, v206, v206
    v_mul_f32 v60, 0x3d372713, v60
    v_add_f32 v60, 1.0, v60
    v_mul_f32 v60, v60, v206
    v_mul_f32 v60, 0xc0135761, v60
    v_mul_f32 v61, v207, v207
    v_mul_f32 v61, 0x3d372713, v61
    v_add_f32 v61, 1.0, v61
    v_mul_f32 v61, v61, v207
    v_mul_f32 v61, 0xc0135761, v61
    v_exp_f32 v58, v58
    v_exp_f32 v59, v59
    v_exp_f32 v60, v60
    v_exp_f32 v61, v61
    s_nop 0
    v_add_f32 v58, 1.0, v58
    v_add_f32 v59, 1.0, v59
    v_add_f32 v60, 1.0, v60
    v_add_f32 v61, 1.0, v61
    v_rcp_f32 v58, v58
    v_rcp_f32 v59, v59
    v_rcp_f32 v60, v60
    v_rcp_f32 v61, v61
    s_nop 0
    v_mul_f32 v204, v204, v58
    v_mul_f32 v205, v205, v59
    v_mul_f32 v206, v206, v60
    v_mul_f32 v207, v207, v61
    v_cvt_pk_bf16_f32 v204, v204, v205
    v_cvt_pk_bf16_f32 v205, v206, v207
    ds_write_b64 v71, v[204:205] offset:6688
    v_cvt_pk_bf16_f32 v32, v208, v209
    v_lshlrev_b32 v208, 16, v32
    v_and_b32 v209, 0xffff0000, v32
    v_cvt_pk_bf16_f32 v32, v210, v211
    v_lshlrev_b32 v210, 16, v32
    v_and_b32 v211, 0xffff0000, v32
    v_mul_f32 v58, v208, v208
    v_mul_f32 v58, 0x3d372713, v58
    v_add_f32 v58, 1.0, v58
    v_mul_f32 v58, v58, v208
    v_mul_f32 v58, 0xc0135761, v58
    v_mul_f32 v59, v209, v209
    v_mul_f32 v59, 0x3d372713, v59
    v_add_f32 v59, 1.0, v59
    v_mul_f32 v59, v59, v209
    v_mul_f32 v59, 0xc0135761, v59
    v_mul_f32 v60, v210, v210
    v_mul_f32 v60, 0x3d372713, v60
    v_add_f32 v60, 1.0, v60
    v_mul_f32 v60, v60, v210
    v_mul_f32 v60, 0xc0135761, v60
    v_mul_f32 v61, v211, v211
    v_mul_f32 v61, 0x3d372713, v61
    v_add_f32 v61, 1.0, v61
    v_mul_f32 v61, v61, v211
    v_mul_f32 v61, 0xc0135761, v61
    v_exp_f32 v58, v58
    v_exp_f32 v59, v59
    v_exp_f32 v60, v60
    v_exp_f32 v61, v61
    s_nop 0
    v_add_f32 v58, 1.0, v58
    v_add_f32 v59, 1.0, v59
    v_add_f32 v60, 1.0, v60
    v_add_f32 v61, 1.0, v61
    v_rcp_f32 v58, v58
    v_rcp_f32 v59, v59
    v_rcp_f32 v60, v60
    v_rcp_f32 v61, v61
    s_nop 0
    v_mul_f32 v208, v208, v58
    v_mul_f32 v209, v209, v59
    v_mul_f32 v210, v210, v60
    v_mul_f32 v211, v211, v61
    v_cvt_pk_bf16_f32 v208, v208, v209
    v_cvt_pk_bf16_f32 v209, v210, v211
    ds_write_b64 v71, v[208:209] offset:6720
    v_cvt_pk_bf16_f32 v32, v212, v213
    v_lshlrev_b32 v212, 16, v32
    v_and_b32 v213, 0xffff0000, v32
    v_cvt_pk_bf16_f32 v32, v214, v215
    v_lshlrev_b32 v214, 16, v32
    v_and_b32 v215, 0xffff0000, v32
    v_mul_f32 v58, v212, v212
    v_mul_f32 v58, 0x3d372713, v58
    v_add_f32 v58, 1.0, v58
    v_mul_f32 v58, v58, v212
    v_mul_f32 v58, 0xc0135761, v58
    v_mul_f32 v59, v213, v213
    v_mul_f32 v59, 0x3d372713, v59
    v_add_f32 v59, 1.0, v59
    v_mul_f32 v59, v59, v213
    v_mul_f32 v59, 0xc0135761, v59
    v_mul_f32 v60, v214, v214
    v_mul_f32 v60, 0x3d372713, v60
    v_add_f32 v60, 1.0, v60
    v_mul_f32 v60, v60, v214
    v_mul_f32 v60, 0xc0135761, v60
    v_mul_f32 v61, v215, v215
    v_mul_f32 v61, 0x3d372713, v61
    v_add_f32 v61, 1.0, v61
    v_mul_f32 v61, v61, v215
    v_mul_f32 v61, 0xc0135761, v61
    v_exp_f32 v58, v58
    v_exp_f32 v59, v59
    v_exp_f32 v60, v60
    v_exp_f32 v61, v61
    s_nop 0
    v_add_f32 v58, 1.0, v58
    v_add_f32 v59, 1.0, v59
    v_add_f32 v60, 1.0, v60
    v_add_f32 v61, 1.0, v61
    v_rcp_f32 v58, v58
    v_rcp_f32 v59, v59
    v_rcp_f32 v60, v60
    v_rcp_f32 v61, v61
    s_nop 0
    v_mul_f32 v212, v212, v58
    v_mul_f32 v213, v213, v59
    v_mul_f32 v214, v214, v60
    v_mul_f32 v215, v215, v61
    v_cvt_pk_bf16_f32 v212, v212, v213
    v_cvt_pk_bf16_f32 v213, v214, v215
    ds_write_b64 v71, v[212:213] offset:6752
    v_cvt_pk_bf16_f32 v32, v216, v217
    v_lshlrev_b32 v216, 16, v32
    v_and_b32 v217, 0xffff0000, v32
    v_cvt_pk_bf16_f32 v32, v218, v219
    v_lshlrev_b32 v218, 16, v32
    v_and_b32 v219, 0xffff0000, v32
    v_mul_f32 v58, v216, v216
    v_mul_f32 v58, 0x3d372713, v58
    v_add_f32 v58, 1.0, v58
    v_mul_f32 v58, v58, v216
    v_mul_f32 v58, 0xc0135761, v58
    v_mul_f32 v59, v217, v217
    v_mul_f32 v59, 0x3d372713, v59
    v_add_f32 v59, 1.0, v59
    v_mul_f32 v59, v59, v217
    v_mul_f32 v59, 0xc0135761, v59
    v_mul_f32 v60, v218, v218
    v_mul_f32 v60, 0x3d372713, v60
    v_add_f32 v60, 1.0, v60
    v_mul_f32 v60, v60, v218
    v_mul_f32 v60, 0xc0135761, v60
    v_mul_f32 v61, v219, v219
    v_mul_f32 v61, 0x3d372713, v61
    v_add_f32 v61, 1.0, v61
    v_mul_f32 v61, v61, v219
    v_mul_f32 v61, 0xc0135761, v61
    v_exp_f32 v58, v58
    v_exp_f32 v59, v59
    v_exp_f32 v60, v60
    v_exp_f32 v61, v61
    s_nop 0
    v_add_f32 v58, 1.0, v58
    v_add_f32 v59, 1.0, v59
    v_add_f32 v60, 1.0, v60
    v_add_f32 v61, 1.0, v61
    v_rcp_f32 v58, v58
    v_rcp_f32 v59, v59
    v_rcp_f32 v60, v60
    v_rcp_f32 v61, v61
    s_nop 0
    v_mul_f32 v216, v216, v58
    v_mul_f32 v217, v217, v59
    v_mul_f32 v218, v218, v60
    v_mul_f32 v219, v219, v61
    v_cvt_pk_bf16_f32 v216, v216, v217
    v_cvt_pk_bf16_f32 v217, v218, v219
    ds_write_b64 v71, v[216:217] offset:6784
    v_cvt_pk_bf16_f32 v32, v220, v221
    v_lshlrev_b32 v220, 16, v32
    v_and_b32 v221, 0xffff0000, v32
    v_cvt_pk_bf16_f32 v32, v222, v223
    v_lshlrev_b32 v222, 16, v32
    v_and_b32 v223, 0xffff0000, v32
    v_mul_f32 v58, v220, v220
    v_mul_f32 v58, 0x3d372713, v58
    v_add_f32 v58, 1.0, v58
    v_mul_f32 v58, v58, v220
    v_mul_f32 v58, 0xc0135761, v58
    v_mul_f32 v59, v221, v221
    v_mul_f32 v59, 0x3d372713, v59
    v_add_f32 v59, 1.0, v59
    v_mul_f32 v59, v59, v221
    v_mul_f32 v59, 0xc0135761, v59
    v_mul_f32 v60, v222, v222
    v_mul_f32 v60, 0x3d372713, v60
    v_add_f32 v60, 1.0, v60
    v_mul_f32 v60, v60, v222
    v_mul_f32 v60, 0xc0135761, v60
    v_mul_f32 v61, v223, v223
    v_mul_f32 v61, 0x3d372713, v61
    v_add_f32 v61, 1.0, v61
    v_mul_f32 v61, v61, v223
    v_mul_f32 v61, 0xc0135761, v61
    v_exp_f32 v58, v58
    v_exp_f32 v59, v59
    v_exp_f32 v60, v60
    v_exp_f32 v61, v61
    s_nop 0
    v_add_f32 v58, 1.0, v58
    v_add_f32 v59, 1.0, v59
    v_add_f32 v60, 1.0, v60
    v_add_f32 v61, 1.0, v61
    v_rcp_f32 v58, v58
    v_rcp_f32 v59, v59
    v_rcp_f32 v60, v60
    v_rcp_f32 v61, v61
    s_nop 0
    v_mul_f32 v220, v220, v58
    v_mul_f32 v221, v221, v59
    v_mul_f32 v222, v222, v60
    v_mul_f32 v223, v223, v61
    v_cvt_pk_bf16_f32 v220, v220, v221
    v_cvt_pk_bf16_f32 v221, v222, v223
    ds_write_b64 v71, v[220:221] offset:6816
    v_cvt_pk_bf16_f32 v32, v224, v225
    v_lshlrev_b32 v224, 16, v32
    v_and_b32 v225, 0xffff0000, v32
    v_cvt_pk_bf16_f32 v32, v226, v227
    v_lshlrev_b32 v226, 16, v32
    v_and_b32 v227, 0xffff0000, v32
    v_mul_f32 v58, v224, v224
    v_mul_f32 v58, 0x3d372713, v58
    v_add_f32 v58, 1.0, v58
    v_mul_f32 v58, v58, v224
    v_mul_f32 v58, 0xc0135761, v58
    v_mul_f32 v59, v225, v225
    v_mul_f32 v59, 0x3d372713, v59
    v_add_f32 v59, 1.0, v59
    v_mul_f32 v59, v59, v225
    v_mul_f32 v59, 0xc0135761, v59
    v_mul_f32 v60, v226, v226
    v_mul_f32 v60, 0x3d372713, v60
    v_add_f32 v60, 1.0, v60
    v_mul_f32 v60, v60, v226
    v_mul_f32 v60, 0xc0135761, v60
    v_mul_f32 v61, v227, v227
    v_mul_f32 v61, 0x3d372713, v61
    v_add_f32 v61, 1.0, v61
    v_mul_f32 v61, v61, v227
    v_mul_f32 v61, 0xc0135761, v61
    v_exp_f32 v58, v58
    v_exp_f32 v59, v59
    v_exp_f32 v60, v60
    v_exp_f32 v61, v61
    s_nop 0
    v_add_f32 v58, 1.0, v58
    v_add_f32 v59, 1.0, v59
    v_add_f32 v60, 1.0, v60
    v_add_f32 v61, 1.0, v61
    v_rcp_f32 v58, v58
    v_rcp_f32 v59, v59
    v_rcp_f32 v60, v60
    v_rcp_f32 v61, v61
    s_nop 0
    v_mul_f32 v224, v224, v58
    v_mul_f32 v225, v225, v59
    v_mul_f32 v226, v226, v60
    v_mul_f32 v227, v227, v61
    v_cvt_pk_bf16_f32 v224, v224, v225
    v_cvt_pk_bf16_f32 v225, v226, v227
    ds_write_b64 v71, v[224:225] offset:9984
    v_cvt_pk_bf16_f32 v32, v228, v229
    v_lshlrev_b32 v228, 16, v32
    v_and_b32 v229, 0xffff0000, v32
    v_cvt_pk_bf16_f32 v32, v230, v231
    v_lshlrev_b32 v230, 16, v32
    v_and_b32 v231, 0xffff0000, v32
    v_mul_f32 v58, v228, v228
    v_mul_f32 v58, 0x3d372713, v58
    v_add_f32 v58, 1.0, v58
    v_mul_f32 v58, v58, v228
    v_mul_f32 v58, 0xc0135761, v58
    v_mul_f32 v59, v229, v229
    v_mul_f32 v59, 0x3d372713, v59
    v_add_f32 v59, 1.0, v59
    v_mul_f32 v59, v59, v229
    v_mul_f32 v59, 0xc0135761, v59
    v_mul_f32 v60, v230, v230
    v_mul_f32 v60, 0x3d372713, v60
    v_add_f32 v60, 1.0, v60
    v_mul_f32 v60, v60, v230
    v_mul_f32 v60, 0xc0135761, v60
    v_mul_f32 v61, v231, v231
    v_mul_f32 v61, 0x3d372713, v61
    v_add_f32 v61, 1.0, v61
    v_mul_f32 v61, v61, v231
    v_mul_f32 v61, 0xc0135761, v61
    v_exp_f32 v58, v58
    v_exp_f32 v59, v59
    v_exp_f32 v60, v60
    v_exp_f32 v61, v61
    s_nop 0
    v_add_f32 v58, 1.0, v58
    v_add_f32 v59, 1.0, v59
    v_add_f32 v60, 1.0, v60
    v_add_f32 v61, 1.0, v61
    v_rcp_f32 v58, v58
    v_rcp_f32 v59, v59
    v_rcp_f32 v60, v60
    v_rcp_f32 v61, v61
    s_nop 0
    v_mul_f32 v228, v228, v58
    v_mul_f32 v229, v229, v59
    v_mul_f32 v230, v230, v60
    v_mul_f32 v231, v231, v61
    v_cvt_pk_bf16_f32 v228, v228, v229
    v_cvt_pk_bf16_f32 v229, v230, v231
    ds_write_b64 v71, v[228:229] offset:10016
    v_cvt_pk_bf16_f32 v32, v232, v233
    v_lshlrev_b32 v232, 16, v32
    v_and_b32 v233, 0xffff0000, v32
    v_cvt_pk_bf16_f32 v32, v234, v235
    v_lshlrev_b32 v234, 16, v32
    v_and_b32 v235, 0xffff0000, v32
    v_mul_f32 v58, v232, v232
    v_mul_f32 v58, 0x3d372713, v58
    v_add_f32 v58, 1.0, v58
    v_mul_f32 v58, v58, v232
    v_mul_f32 v58, 0xc0135761, v58
    v_mul_f32 v59, v233, v233
    v_mul_f32 v59, 0x3d372713, v59
    v_add_f32 v59, 1.0, v59
    v_mul_f32 v59, v59, v233
    v_mul_f32 v59, 0xc0135761, v59
    v_mul_f32 v60, v234, v234
    v_mul_f32 v60, 0x3d372713, v60
    v_add_f32 v60, 1.0, v60
    v_mul_f32 v60, v60, v234
    v_mul_f32 v60, 0xc0135761, v60
    v_mul_f32 v61, v235, v235
    v_mul_f32 v61, 0x3d372713, v61
    v_add_f32 v61, 1.0, v61
    v_mul_f32 v61, v61, v235
    v_mul_f32 v61, 0xc0135761, v61
    v_exp_f32 v58, v58
    v_exp_f32 v59, v59
    v_exp_f32 v60, v60
    v_exp_f32 v61, v61
    s_nop 0
    v_add_f32 v58, 1.0, v58
    v_add_f32 v59, 1.0, v59
    v_add_f32 v60, 1.0, v60
    v_add_f32 v61, 1.0, v61
    v_rcp_f32 v58, v58
    v_rcp_f32 v59, v59
    v_rcp_f32 v60, v60
    v_rcp_f32 v61, v61
    s_nop 0
    v_mul_f32 v232, v232, v58
    v_mul_f32 v233, v233, v59
    v_mul_f32 v234, v234, v60
    v_mul_f32 v235, v235, v61
    v_cvt_pk_bf16_f32 v232, v232, v233
    v_cvt_pk_bf16_f32 v233, v234, v235
    ds_write_b64 v71, v[232:233] offset:10048
    v_cvt_pk_bf16_f32 v32, v236, v237
    v_lshlrev_b32 v236, 16, v32
    v_and_b32 v237, 0xffff0000, v32
    v_cvt_pk_bf16_f32 v32, v238, v239
    v_lshlrev_b32 v238, 16, v32
    v_and_b32 v239, 0xffff0000, v32
    v_mul_f32 v58, v236, v236
    v_mul_f32 v58, 0x3d372713, v58
    v_add_f32 v58, 1.0, v58
    v_mul_f32 v58, v58, v236
    v_mul_f32 v58, 0xc0135761, v58
    v_mul_f32 v59, v237, v237
    v_mul_f32 v59, 0x3d372713, v59
    v_add_f32 v59, 1.0, v59
    v_mul_f32 v59, v59, v237
    v_mul_f32 v59, 0xc0135761, v59
    v_mul_f32 v60, v238, v238
    v_mul_f32 v60, 0x3d372713, v60
    v_add_f32 v60, 1.0, v60
    v_mul_f32 v60, v60, v238
    v_mul_f32 v60, 0xc0135761, v60
    v_mul_f32 v61, v239, v239
    v_mul_f32 v61, 0x3d372713, v61
    v_add_f32 v61, 1.0, v61
    v_mul_f32 v61, v61, v239
    v_mul_f32 v61, 0xc0135761, v61
    v_exp_f32 v58, v58
    v_exp_f32 v59, v59
    v_exp_f32 v60, v60
    v_exp_f32 v61, v61
    s_nop 0
    v_add_f32 v58, 1.0, v58
    v_add_f32 v59, 1.0, v59
    v_add_f32 v60, 1.0, v60
    v_add_f32 v61, 1.0, v61
    v_rcp_f32 v58, v58
    v_rcp_f32 v59, v59
    v_rcp_f32 v60, v60
    v_rcp_f32 v61, v61
    s_nop 0
    v_mul_f32 v236, v236, v58
    v_mul_f32 v237, v237, v59
    v_mul_f32 v238, v238, v60
    v_mul_f32 v239, v239, v61
    v_cvt_pk_bf16_f32 v236, v236, v237
    v_cvt_pk_bf16_f32 v237, v238, v239
    ds_write_b64 v71, v[236:237] offset:10080
    v_cvt_pk_bf16_f32 v32, v240, v241
    v_lshlrev_b32 v240, 16, v32
    v_and_b32 v241, 0xffff0000, v32
    v_cvt_pk_bf16_f32 v32, v242, v243
    v_lshlrev_b32 v242, 16, v32
    v_and_b32 v243, 0xffff0000, v32
    v_mul_f32 v58, v240, v240
    v_mul_f32 v58, 0x3d372713, v58
    v_add_f32 v58, 1.0, v58
    v_mul_f32 v58, v58, v240
    v_mul_f32 v58, 0xc0135761, v58
    v_mul_f32 v59, v241, v241
    v_mul_f32 v59, 0x3d372713, v59
    v_add_f32 v59, 1.0, v59
    v_mul_f32 v59, v59, v241
    v_mul_f32 v59, 0xc0135761, v59
    v_mul_f32 v60, v242, v242
    v_mul_f32 v60, 0x3d372713, v60
    v_add_f32 v60, 1.0, v60
    v_mul_f32 v60, v60, v242
    v_mul_f32 v60, 0xc0135761, v60
    v_mul_f32 v61, v243, v243
    v_mul_f32 v61, 0x3d372713, v61
    v_add_f32 v61, 1.0, v61
    v_mul_f32 v61, v61, v243
    v_mul_f32 v61, 0xc0135761, v61
    v_exp_f32 v58, v58
    v_exp_f32 v59, v59
    v_exp_f32 v60, v60
    v_exp_f32 v61, v61
    s_nop 0
    v_add_f32 v58, 1.0, v58
    v_add_f32 v59, 1.0, v59
    v_add_f32 v60, 1.0, v60
    v_add_f32 v61, 1.0, v61
    v_rcp_f32 v58, v58
    v_rcp_f32 v59, v59
    v_rcp_f32 v60, v60
    v_rcp_f32 v61, v61
    s_nop 0
    v_mul_f32 v240, v240, v58
    v_mul_f32 v241, v241, v59
    v_mul_f32 v242, v242, v60
    v_mul_f32 v243, v243, v61
    v_cvt_pk_bf16_f32 v240, v240, v241
    v_cvt_pk_bf16_f32 v241, v242, v243
    ds_write_b64 v71, v[240:241] offset:10112
    v_cvt_pk_bf16_f32 v32, v244, v245
    v_lshlrev_b32 v244, 16, v32
    v_and_b32 v245, 0xffff0000, v32
    v_cvt_pk_bf16_f32 v32, v246, v247
    v_lshlrev_b32 v246, 16, v32
    v_and_b32 v247, 0xffff0000, v32
    v_mul_f32 v58, v244, v244
    v_mul_f32 v58, 0x3d372713, v58
    v_add_f32 v58, 1.0, v58
    v_mul_f32 v58, v58, v244
    v_mul_f32 v58, 0xc0135761, v58
    v_mul_f32 v59, v245, v245
    v_mul_f32 v59, 0x3d372713, v59
    v_add_f32 v59, 1.0, v59
    v_mul_f32 v59, v59, v245
    v_mul_f32 v59, 0xc0135761, v59
    v_mul_f32 v60, v246, v246
    v_mul_f32 v60, 0x3d372713, v60
    v_add_f32 v60, 1.0, v60
    v_mul_f32 v60, v60, v246
    v_mul_f32 v60, 0xc0135761, v60
    v_mul_f32 v61, v247, v247
    v_mul_f32 v61, 0x3d372713, v61
    v_add_f32 v61, 1.0, v61
    v_mul_f32 v61, v61, v247
    v_mul_f32 v61, 0xc0135761, v61
    v_exp_f32 v58, v58
    v_exp_f32 v59, v59
    v_exp_f32 v60, v60
    v_exp_f32 v61, v61
    s_nop 0
    v_add_f32 v58, 1.0, v58
    v_add_f32 v59, 1.0, v59
    v_add_f32 v60, 1.0, v60
    v_add_f32 v61, 1.0, v61
    v_rcp_f32 v58, v58
    v_rcp_f32 v59, v59
    v_rcp_f32 v60, v60
    v_rcp_f32 v61, v61
    s_nop 0
    v_mul_f32 v244, v244, v58
    v_mul_f32 v245, v245, v59
    v_mul_f32 v246, v246, v60
    v_mul_f32 v247, v247, v61
    v_cvt_pk_bf16_f32 v244, v244, v245
    v_cvt_pk_bf16_f32 v245, v246, v247
    ds_write_b64 v71, v[244:245] offset:10144
    s_waitcnt lgkmcnt(0)
    s_mov_b32 s36, 357913942
    s_mul_i32 s35, s33, 128
    s_lshr_b32 s37, s3, 1
    s_mul_i32 s37, s37, 64
    s_add_u32 s35, s35, s37
    s_mul_i32 s35, s35, 6144
    s_mul_i32 s37, s31, 384
    s_add_u32 s35, s35, s37
    s_and_b32 s37, s3, 1
    s_mul_i32 s37, s37, 192
    s_add_u32 s35, s35, s37
    s_mov_b32 s37, 6144
    v_add_u32 v27, 0, v2
    v_mul_hi_u32 v28, v27, s36
    v_mul_u32_u24 v29, 12, v28
    v_sub_u32 v29, v27, v29
    v_mul_u32_u24 v30, 208, v28
    v_lshl_add_u32 v30, v29, 4, v30
    v_add_u32 v30, s52, v30
    ds_read_b128 v[152:155], v30
    v_mul_lo_u32 v32, v28, s37
    v_lshl_add_u32 v34, v29, 4, v32
    s_waitcnt lgkmcnt(0)
    buffer_store_dwordx4 v[152:155], v34, s[20:23], s35 offen
    v_add_u32 v27, 64, v2
    v_mul_hi_u32 v28, v27, s36
    v_mul_u32_u24 v29, 12, v28
    v_sub_u32 v29, v27, v29
    v_mul_u32_u24 v30, 208, v28
    v_lshl_add_u32 v30, v29, 4, v30
    v_add_u32 v30, s52, v30
    ds_read_b128 v[156:159], v30
    v_mul_lo_u32 v32, v28, s37
    v_lshl_add_u32 v35, v29, 4, v32
    s_waitcnt lgkmcnt(0)
    buffer_store_dwordx4 v[156:159], v35, s[20:23], s35 offen
    v_add_u32 v27, 128, v2
    v_mul_hi_u32 v28, v27, s36
    v_mul_u32_u24 v29, 12, v28
    v_sub_u32 v29, v27, v29
    v_mul_u32_u24 v30, 208, v28
    v_lshl_add_u32 v30, v29, 4, v30
    v_add_u32 v30, s52, v30
    ds_read_b128 v[160:163], v30
    v_mul_lo_u32 v32, v28, s37
    v_lshl_add_u32 v36, v29, 4, v32
    s_waitcnt lgkmcnt(0)
    buffer_store_dwordx4 v[160:163], v36, s[20:23], s35 offen
    v_add_u32 v27, 192, v2
    v_mul_hi_u32 v28, v27, s36
    v_mul_u32_u24 v29, 12, v28
    v_sub_u32 v29, v27, v29
    v_mul_u32_u24 v30, 208, v28
    v_lshl_add_u32 v30, v29, 4, v30
    v_add_u32 v30, s52, v30
    ds_read_b128 v[164:167], v30
    v_mul_lo_u32 v32, v28, s37
    v_lshl_add_u32 v37, v29, 4, v32
    s_waitcnt lgkmcnt(0)
    buffer_store_dwordx4 v[164:167], v37, s[20:23], s35 offen
    v_add_u32 v27, 256, v2
    v_mul_hi_u32 v28, v27, s36
    v_mul_u32_u24 v29, 12, v28
    v_sub_u32 v29, v27, v29
    v_mul_u32_u24 v30, 208, v28
    v_lshl_add_u32 v30, v29, 4, v30
    v_add_u32 v30, s52, v30
    ds_read_b128 v[168:171], v30
    v_mul_lo_u32 v32, v28, s37
    v_lshl_add_u32 v38, v29, 4, v32
    s_waitcnt lgkmcnt(0)
    buffer_store_dwordx4 v[168:171], v38, s[20:23], s35 offen
    v_add_u32 v27, 320, v2
    v_mul_hi_u32 v28, v27, s36
    v_mul_u32_u24 v29, 12, v28
    v_sub_u32 v29, v27, v29
    v_mul_u32_u24 v30, 208, v28
    v_lshl_add_u32 v30, v29, 4, v30
    v_add_u32 v30, s52, v30
    ds_read_b128 v[172:175], v30
    v_mul_lo_u32 v32, v28, s37
    v_lshl_add_u32 v39, v29, 4, v32
    s_waitcnt lgkmcnt(0)
    buffer_store_dwordx4 v[172:175], v39, s[20:23], s35 offen
    v_add_u32 v27, 384, v2
    v_mul_hi_u32 v28, v27, s36
    v_mul_u32_u24 v29, 12, v28
    v_sub_u32 v29, v27, v29
    v_mul_u32_u24 v30, 208, v28
    v_lshl_add_u32 v30, v29, 4, v30
    v_add_u32 v30, s52, v30
    ds_read_b128 v[176:179], v30
    v_mul_lo_u32 v32, v28, s37
    v_lshl_add_u32 v40, v29, 4, v32
    s_waitcnt lgkmcnt(0)
    buffer_store_dwordx4 v[176:179], v40, s[20:23], s35 offen
    v_add_u32 v27, 448, v2
    v_mul_hi_u32 v28, v27, s36
    v_mul_u32_u24 v29, 12, v28
    v_sub_u32 v29, v27, v29
    v_mul_u32_u24 v30, 208, v28
    v_lshl_add_u32 v30, v29, 4, v30
    v_add_u32 v30, s52, v30
    ds_read_b128 v[180:183], v30
    v_mul_lo_u32 v32, v28, s37
    v_lshl_add_u32 v41, v29, 4, v32
    s_waitcnt lgkmcnt(0)
    buffer_store_dwordx4 v[180:183], v41, s[20:23], s35 offen
    v_add_u32 v27, 512, v2
    v_mul_hi_u32 v28, v27, s36
    v_mul_u32_u24 v29, 12, v28
    v_sub_u32 v29, v27, v29
    v_mul_u32_u24 v30, 208, v28
    v_lshl_add_u32 v30, v29, 4, v30
    v_add_u32 v30, s52, v30
    ds_read_b128 v[152:155], v30
    v_mul_lo_u32 v32, v28, s37
    v_lshl_add_u32 v34, v29, 4, v32
    s_waitcnt lgkmcnt(0)
    buffer_store_dwordx4 v[152:155], v34, s[20:23], s35 offen
    v_add_u32 v27, 576, v2
    v_mul_hi_u32 v28, v27, s36
    v_mul_u32_u24 v29, 12, v28
    v_sub_u32 v29, v27, v29
    v_mul_u32_u24 v30, 208, v28
    v_lshl_add_u32 v30, v29, 4, v30
    v_add_u32 v30, s52, v30
    ds_read_b128 v[156:159], v30
    v_mul_lo_u32 v32, v28, s37
    v_lshl_add_u32 v35, v29, 4, v32
    s_waitcnt lgkmcnt(0)
    buffer_store_dwordx4 v[156:159], v35, s[20:23], s35 offen
    v_add_u32 v27, 640, v2
    v_mul_hi_u32 v28, v27, s36
    v_mul_u32_u24 v29, 12, v28
    v_sub_u32 v29, v27, v29
    v_mul_u32_u24 v30, 208, v28
    v_lshl_add_u32 v30, v29, 4, v30
    v_add_u32 v30, s52, v30
    ds_read_b128 v[160:163], v30
    v_mul_lo_u32 v32, v28, s37
    v_lshl_add_u32 v36, v29, 4, v32
    s_waitcnt lgkmcnt(0)
    buffer_store_dwordx4 v[160:163], v36, s[20:23], s35 offen
    v_add_u32 v27, 704, v2
    v_mul_hi_u32 v28, v27, s36
    v_mul_u32_u24 v29, 12, v28
    v_sub_u32 v29, v27, v29
    v_mul_u32_u24 v30, 208, v28
    v_lshl_add_u32 v30, v29, 4, v30
    v_add_u32 v30, s52, v30
    ds_read_b128 v[164:167], v30
    v_mul_lo_u32 v32, v28, s37
    v_lshl_add_u32 v37, v29, 4, v32
    s_waitcnt lgkmcnt(0)
    buffer_store_dwordx4 v[164:167], v37, s[20:23], s35 offen
    s_waitcnt vmcnt(0)
L_dit_fc1_kernel_1:
    s_endpgm
.section .rodata,"a"
.p2align 6
.amdhsa_kernel dit_fc1_kernel
  .amdhsa_next_free_vgpr 248
  .amdhsa_next_free_sgpr 100
  .amdhsa_accum_offset 248
  .amdhsa_group_segment_fixed_size 0
  .amdhsa_kernarg_size 80
  .amdhsa_user_sgpr_count 2
  .amdhsa_user_sgpr_kernarg_segment_ptr 1
  .amdhsa_system_sgpr_workgroup_id_x 1
.end_amdhsa_kernel
.text
.globl dit_fc2_kernel
.p2align 8
.type dit_fc2_kernel,@function
dit_fc2_kernel:
    s_cmp_ge_u32 s2, 256
    s_cbranch_scc1 L_dit_fc2_kernel_1
    s_load_dwordx2 s[4:5], s[0:1], 72
    s_load_dwordx2 s[6:7], s[0:1], 48
    s_load_dwordx2 s[8:9], s[0:1], 56
    s_load_dwordx2 s[10:11], s[0:1], 72
    s_load_dwordx2 s[40:41], s[0:1], 72
    s_and_b32 s54, s2, 7
    s_mul_i32 s54, s54, 32
    s_lshr_b32 s55, s2, 3
    s_add_u32 s54, s54, s55
    s_mul_hi_u32 s30, s54, 536870913
    s_mul_i32 s31, s30, 8
    s_sub_u32 s31, s54, s31
    s_mul_hi_u32 s32, s30, 134217729
    s_mul_i32 s33, s32, 32
    s_sub_u32 s33, s30, s33
    v_lshrrev_b32 v1, 6, v0
    v_and_b32 v2, 63, v0
    s_nop 0
    v_readfirstlane_b32 s3, v1
    v_and_b32 v1, 3, v1
    s_lshr_b32 s53, s3, 2
    s_and_b32 s3, s3, 3
    s_waitcnt lgkmcnt(0)
    s_mul_i32 s34, s32, 0
    s_add_u32 s34, s34, 46137344
    s_add_u32 s12, s4, s34
    s_addc_u32 s13, s5, 0
    s_mov_b32 s14, 12582912
    s_mov_b32 s15, 0x00020000
    s_mul_i32 s34, s32, 0
    s_add_u32 s34, s34, 0
    s_add_u32 s16, s6, s34
    s_addc_u32 s17, s7, 0
    s_mov_b32 s18, 4718592
    s_mov_b32 s19, 0x00020000
    s_mul_i32 s34, s32, 0
    s_add_u32 s34, s34, 0
    s_add_u32 s20, s8, s34
    s_addc_u32 s21, s9, 0
    s_mov_b32 s22, 3145728
    s_mov_b32 s23, 0x00020000
    s_mov_b32 s24, s10
    s_mov_b32 s25, s11
    s_mov_b32 s26, 36864
    s_mov_b32 s27, 0x00020000
    s_add_u32 s44, s40, 37748736
    s_addc_u32 s45, s41, 0
    s_mov_b32 s46, 3145728
    s_mov_b32 s47, 0x00020000
    v_lshrrev_b32 v27, 3, v2
    v_and_b32 v28, 7, v2
    v_xor_b32 v28, v28, v27
    s_mul_i32 s35, s33, 64
    s_lshl_b32 s36, s3, 3
    s_add_u32 s35, s35, s36
    v_add_u32 v29, s35, v27
    s_mov_b32 s36, 6144
    v_mul_lo_u32 v29, v29, s36
    v_lshl_add_u32 v4, v28, 4, v29
    s_mov_b32 s36, 357913942
    s_mul_i32 s35, s31, 192
    s_mov_b32 s37, 1536
    s_lshl_b32 s43, s3, 6
    v_add_u32 v29, s43, v2
    v_add_u32 v29, 0, v29
    v_mul_hi_u32 v30, v29, s36
    v_mul_u32_u24 v31, 12, v30
    v_sub_u32 v31, v29, v31
    v_bfe_u32 v33, v30, 3, 1
    v_mov_b32 v32, v33
    v_lshrrev_b32 v33, 1, v31
    v_xor_b32 v33, v33, v32
    v_and_b32 v31, 1, v31
    v_lshl_or_b32 v31, v33, 1, v31
    v_mul_lo_u32 v32, v30, s37
    v_lshl_add_u32 v32, v31, 4, v32
    v_add_u32 v5, s35, v32
    s_lshl_b32 s43, s3, 6
    v_add_u32 v29, s43, v2
    v_add_u32 v29, 256, v29
    v_mul_hi_u32 v30, v29, s36
    v_mul_u32_u24 v31, 12, v30
    v_sub_u32 v31, v29, v31
    v_bfe_u32 v33, v30, 3, 1
    v_mov_b32 v32, v33
    v_lshrrev_b32 v33, 1, v31
    v_xor_b32 v33, v33, v32
    v_and_b32 v31, 1, v31
    v_lshl_or_b32 v31, v33, 1, v31
    v_mul_lo_u32 v32, v30, s37
    v_lshl_add_u32 v32, v31, 4, v32
    v_add_u32 v6, s35, v32
    s_lshl_b32 s43, s3, 6
    v_add_u32 v29, s43, v2
    v_add_u32 v29, 512, v29
    v_mul_hi_u32 v30, v29, s36
    v_mul_u32_u24 v31, 12, v30
    v_sub_u32 v31, v29, v31
    v_bfe_u32 v33, v30, 3, 1
    v_mov_b32 v32, v33
    v_lshrrev_b32 v33, 1, v31
    v_xor_b32 v33, v33, v32
    v_and_b32 v31, 1, v31
    v_lshl_or_b32 v31, v33, 1, v31
    v_mul_lo_u32 v32, v30, s37
    v_lshl_add_u32 v32, v31, 4, v32
    v_add_u32 v7, s35, v32
    v_lshrrev_b32 v27, 1, v1
    v_and_b32 v28, 1, v1
    v_and_b32 v29, 15, v2
    v_lshrrev_b32 v30, 4, v2
    v_mul_u32_u24 v31, 32, v27
    v_add_u32 v31, v31, v29
    v_and_b32 v32, 7, v2
    v_xor_b32 v32, v32, v30
    v_lshlrev_b32 v32, 4, v32
    v_lshl_add_u32 v11, v31, 7, v32
    v_xor_b32 v12, 64, v11
    v_lshrrev_b32 v31, 2, v29
    v_lshl_add_u32 v31, v30, 3, v31
    v_bfe_u32 v33, v31, 3, 1
    v_mov_b32 v32, v33
    v_mul_u32_u24 v31, 192, v31
    v_and_b32 v33, 3, v2
    v_lshl_add_u32 v31, v33, 3, v31
    v_add_u32 v31, 8192, v31
    v_mul_u32_u24 v33, 3, v28
    v_add_u32 v33, 0, v33
    v_xor_b32 v33, v33, v32
    v_lshl_add_u32 v13, v33, 5, v31
    v_mul_u32_u24 v33, 3, v28
    v_add_u32 v33, 1, v33
    v_xor_b32 v33, v33, v32
    v_lshl_add_u32 v14, v33, 5, v31
    v_mul_u32_u24 v33, 3, v28
    v_add_u32 v33, 2, v33
    v_xor_b32 v33, v33, v32
    v_lshl_add_u32 v15, v33, 5, v31
    v_mov_b32 v112, 0
    v_mov_b32 v113, 0
    v_mov_b32 v114, 0
    v_mov_b32 v115, 0
    v_mov_b32 v116, 0
    v_mov_b32 v117, 0
    v_mov_b32 v118, 0
    v_mov_b32 v119, 0
    v_mov_b32 v120, 0
    v_mov_b32 v121, 0
    v_mov_b32 v122, 0
    v_mov_b32 v123, 0
    v_mov_b32 v124, 0
    v_mov_b32 v125, 0
    v_mov_b32 v126, 0
    v_mov_b32 v127, 0
    v_mov_b32 v128, 0
    v_mov_b32 v129, 0
    v_mov_b32 v130, 0
    v_mov_b32 v131, 0
    v_mov_b32 v132, 0
    v_mov_b32 v133, 0
    v_mov_b32 v134, 0
    v_mov_b32 v135, 0
    s_mov_b32 s38, 0
    s_mov_b32 s39, 0
    s_lshl_b32 s48, s3, 10
    s_mov_b32 s49, s48
    s_mov_b32 s50, 0
    s_mov_b32 s42, 42
    s_cmp_eq_u32 s53, 0
    s_cbranch_scc1 L_dit_fc2_kernel_2
    s_add_u32 m0, s49, 0
    s_add_u32 s51, s38, 0
    buffer_load_dwordx4 v4, s[12:15], s51 offen lds
    s_add_u32 m0, s49, 4096
    s_add_u32 s51, s38, 196608
    buffer_load_dwordx4 v4, s[12:15], s51 offen lds
    s_add_u32 m0, s49, 8192
    s_nop 0
    buffer_load_dwordx4 v5, s[16:19], s39 offen lds
    s_add_u32 m0, s49, 12288
    s_nop 0
    buffer_load_dwordx4 v6, s[16:19], s39 offen lds
    s_add_u32 m0, s49, 16384
    s_nop 0
    buffer_load_dwordx4 v7, s[16:19], s39 offen lds
    s_add_u32 s38, s38, 128
    s_add_u32 s39, s39, 98304
    s_add_u32 s49, s49, 20480
    s_sub_u32 s51, s49, s48
    s_cmp_ge_u32 s51, 143360
    s_cselect_b32 s49, s48, s49
    s_add_u32 m0, s49, 0
    s_add_u32 s51, s38, 0
    buffer_load_dwordx4 v4, s[12:15], s51 offen lds
    s_add_u32 m0, s49, 4096
    s_add_u32 s51, s38, 196608
    buffer_load_dwordx4 v4, s[12:15], s51 offen lds
    s_add_u32 m0, s49, 8192
    s_nop 0
    buffer_load_dwordx4 v5, s[16:19], s39 offen lds
    s_add_u32 m0, s49, 12288
    s_nop 0
    buffer_load_dwordx4 v6, s[16:19], s39 offen lds
    s_add_u32 m0, s49, 16384
    s_nop 0
    buffer_load_dwordx4 v7, s[16:19], s39 offen lds
    s_add_u32 s38, s38, 128
    s_add_u32 s39, s39, 98304
    s_add_u32 s49, s49, 20480
    s_sub_u32 s51, s49, s48
    s_cmp_ge_u32 s51, 143360
    s_cselect_b32 s49, s48, s49
    s_add_u32 m0, s49, 0
    s_add_u32 s51, s38, 0
    buffer_load_dwordx4 v4, s[12:15], s51 offen lds
    s_add_u32 m0, s49, 4096
    s_add_u32 s51, s38, 196608
    buffer_load_dwordx4 v4, s[12:15], s51 offen lds
    s_add_u32 m0, s49, 8192
    s_nop 0
    buffer_load_dwordx4 v5, s[16:19], s39 offen lds
    s_add_u32 m0, s49, 12288
    s_nop 0
    buffer_load_dwordx4 v6, s[16:19], s39 offen lds
    s_add_u32 m0, s49, 16384
    s_nop 0
    buffer_load_dwordx4 v7, s[16:19], s39 offen lds
    s_add_u32 s38, s38, 128
    s_add_u32 s39, s39, 98304
    s_add_u32 s49, s49, 20480
    s_sub_u32 s51, s49, s48
    s_cmp_ge_u32 s51, 143360
    s_cselect_b32 s49, s48, s49
    s_add_u32 m0, s49, 0
    s_add_u32 s51, s38, 0
    buffer_load_dwordx4 v4, s[12:15], s51 offen lds
    s_add_u32 m0, s49, 4096
    s_add_u32 s51, s38, 196608
    buffer_load_dwordx4 v4, s[12:15], s51 offen lds
    s_add_u32 m0, s49, 8192
    s_nop 0
    buffer_load_dwordx4 v5, s[16:19], s39 offen lds
    s_add_u32 m0, s49, 12288
    s_nop 0
    buffer_load_dwordx4 v6, s[16:19], s39 offen lds
    s_add_u32 m0, s49, 16384
    s_nop 0
    buffer_load_dwordx4 v7, s[16:19], s39 offen lds
    s_add_u32 s38, s38, 128
    s_add_u32 s39, s39, 98304
    s_add_u32 s49, s49, 20480
    s_sub_u32 s51, s49, s48
    s_cmp_ge_u32 s51, 143360
    s_cselect_b32 s49, s48, s49
    s_add_u32 m0, s49, 0
    s_add_u32 s51, s38, 0
    buffer_load_dwordx4 v4, s[12:15], s51 offen lds
    s_add_u32 m0, s49, 4096
    s_add_u32 s51, s38, 196608
    buffer_load_dwordx4 v4, s[12:15], s51 offen lds
    s_add_u32 m0, s49, 8192
    s_nop 0
    buffer_load_dwordx4 v5, s[16:19], s39 offen lds
    s_add_u32 m0, s49, 12288
    s_nop 0
    buffer_load_dwordx4 v6, s[16:19], s39 offen lds
    s_add_u32 m0, s49, 16384
    s_nop 0
    buffer_load_dwordx4 v7, s[16:19], s39 offen lds
    s_add_u32 s38, s38, 128
    s_add_u32 s39, s39, 98304
    s_add_u32 s49, s49, 20480
    s_sub_u32 s51, s49, s48
    s_cmp_ge_u32 s51, 143360
    s_cselect_b32 s49, s48, s49
    s_add_u32 m0, s49, 0
    s_add_u32 s51, s38, 0
    buffer_load_dwordx4 v4, s[12:15], s51 offen lds
    s_add_u32 m0, s49, 4096
    s_add_u32 s51, s38, 196608
    buffer_load_dwordx4 v4, s[12:15], s51 offen lds
    s_add_u32 m0, s49, 8192
    s_nop 0
    buffer_load_dwordx4 v5, s[16:19], s39 offen lds
    s_add_u32 m0, s49, 12288
    s_nop 0
    buffer_load_dwordx4 v6, s[16:19], s39 offen lds
    s_add_u32 m0, s49, 16384
    s_nop 0
    buffer_load_dwordx4 v7, s[16:19], s39 offen lds
    s_add_u32 s38, s38, 128
    s_add_u32 s39, s39, 98304
    s_add_u32 s49, s49, 20480
    s_sub_u32 s51, s49, s48
    s_cmp_ge_u32 s51, 143360
    s_cselect_b32 s49, s48, s49
L_dit_fc2_kernel_3:
    s_waitcnt vmcnt(25)
    s_barrier
    s_add_u32 m0, s49, 0
    s_add_u32 s51, s38, 0
    buffer_load_dwordx4 v4, s[12:15], s51 offen lds
    s_add_u32 m0, s49, 4096
    s_add_u32 s51, s38, 196608
    buffer_load_dwordx4 v4, s[12:15], s51 offen lds
    s_add_u32 m0, s49, 8192
    s_nop 0
    buffer_load_dwordx4 v5, s[16:19], s39 offen lds
    s_add_u32 m0, s49, 12288
    s_nop 0
    buffer_load_dwordx4 v6, s[16:19], s39 offen lds
    s_add_u32 m0, s49, 16384
    s_nop 0
    buffer_load_dwordx4 v7, s[16:19], s39 offen lds
    s_add_u32 s38, s38, 128
    s_add_u32 s39, s39, 98304
    s_add_u32 s49, s49, 20480
    s_sub_u32 s51, s49, s48
    s_cmp_ge_u32 s51, 143360
    s_cselect_b32 s49, s48, s49
    s_sub_u32 s42, s42, 1
    s_cmp_lg_u32 s42, 0
    s_cbranch_scc1 L_dit_fc2_kernel_3
    s_waitcnt vmcnt(25)
    s_barrier
    s_waitcnt vmcnt(20)
    s_barrier
    s_waitcnt vmcnt(15)
    s_barrier
    s_waitcnt vmcnt(10)
    s_barrier
    s_waitcnt vmcnt(5)
    s_barrier
    s_waitcnt vmcnt(0)
    s_barrier
    s_barrier
    s_branch L_dit_fc2_kernel_1
L_dit_fc2_kernel_2:
    s_mov_b32 s42, 48
L_dit_fc2_kernel_4:
    s_barrier
    v_add_u32 v19, s50, v11
    v_add_u32 v20, s50, v12
    v_add_u32 v21, s50, v13
    v_add_u32 v22, s50, v14
    v_add_u32 v23, s50, v15
    ds_read_b128 v[72:75], v19 offset:0
    ds_read_b128 v[76:79], v19 offset:2048
    ds_read_b64_tr_b16 v[88:89], v21 offset:0
    ds_read_b64_tr_b16 v[90:91], v21 offset:768
    ds_read_b64_tr_b16 v[92:93], v22 offset:0
    ds_read_b64_tr_b16 v[94:95], v22 offset:768
    ds_read_b64_tr_b16 v[96:97], v23 offset:0
    ds_read_b64_tr_b16 v[98:99], v23 offset:768
    ds_read_b128 v[80:83], v20 offset:0
    ds_read_b128 v[84:87], v20 offset:2048
    ds_read_b64_tr_b16 v[100:101], v21 offset:6144
    ds_read_b64_tr_b16 v[102:103], v21 offset:6912
    ds_read_b64_tr_b16 v[104:105], v22 offset:6144
    ds_read_b64_tr_b16 v[106:107], v22 offset:6912
    ds_read_b64_tr_b16 v[108:109], v23 offset:6144
    ds_read_b64_tr_b16 v[110:111], v23 offset:6912
    s_waitcnt lgkmcnt(8)
    v_mfma_f32_16x16x32_bf16 v[112:115], v[88:91], v[72:75], v[112:115]
    v_mfma_f32_16x16x32_bf16 v[116:119], v[92:95], v[72:75], v[116:119]
    v_mfma_f32_16x16x32_bf16 v[120:123], v[96:99], v[72:75], v[120:123]
    v_mfma_f32_16x16x32_bf16 v[124:127], v[88:91], v[76:79], v[124:127]
    v_mfma_f32_16x16x32_bf16 v[128:131], v[92:95], v[76:79], v[128:131]
    v_mfma_f32_16x16x32_bf16 v[132:135], v[96:99], v[76:79], v[132:135]
    s_waitcnt lgkmcnt(0)
    v_mfma_f32_16x16x32_bf16 v[112:115], v[100:103], v[80:83], v[112:115]
    v_mfma_f32_16x16x32_bf16 v[116:119], v[104:107], v[80:83], v[116:119]
    v_mfma_f32_16x16x32_bf16 v[120:123], v[108:111], v[80:83], v[120:123]
    v_mfma_f32_16x16x32_bf16 v[124:127], v[100:103], v[84:87], v[124:127]
    v_mfma_f32_16x16x32_bf16 v[128:131], v[104:107], v[84:87], v[128:131]
    v_mfma_f32_16x16x32_bf16 v[132:135], v[108:111], v[84:87], v[132:135]
    s_add_u32 s50, s50, 20480
    s_cmp_ge_u32 s50, 143360
    s_cselect_b32 s50, 0, s50
    s_sub_u32 s42, s42, 1
    s_cmp_lg_u32 s42, 0
    s_cbranch_scc1 L_dit_fc2_kernel_4
    s_mul_i32 s35, s33, 64
    v_mul_u32_u24 v32, 32, v27
    v_add3_u32 v32, v32, v29, s35
    s_mul_i32 s36, s31, 96
    v_mul_u32_u24 v33, 48, v28
    v_lshl_add_u32 v33, v30, 2, v33
    v_add_u32 v33, s36, v33
    s_mov_b32 s37, 1536
    v_mul_lo_u32 v31, v32, s37
    v_lshl_add_u32 v31, v33, 1, v31
    s_barrier
    s_mul_i32 s52, s3, 3584
    v_mul_u32_u24 v71, 112, v29
    v_lshl_add_u32 v71, v30, 3, v71
    v_add_u32 v71, s52, v71
    s_lshr_b32 s37, s35, 10
    s_mul_i32 s37, s37, 18432
    s_add_u32 s37, s37, 15360
    v_lshlrev_b32 v33, 2, v33
    buffer_load_dwordx4 v[34:37], v33, s[24:27], s37 offen offset:0
    buffer_load_dwordx4 v[38:41], v33, s[24:27], s37 offen offset:64
    buffer_load_dwordx4 v[42:45], v33, s[24:27], s37 offen offset:128
    s_nop 7
    s_nop 7
    buffer_load_dwordx2 v[46:47], v31, s[44:47], 0 offen offset:0
    buffer_load_dwordx2 v[48:49], v31, s[44:47], 0 offen offset:32
    buffer_load_dwordx2 v[50:51], v31, s[44:47], 0 offen offset:64
    s_waitcnt vmcnt(0)
    v_cvt_pk_bf16_f32 v32, v112, v113
    v_lshlrev_b32 v112, 16, v32
    v_and_b32 v113, 0xffff0000, v32
    v_cvt_pk_bf16_f32 v32, v114, v115
    v_lshlrev_b32 v114, 16, v32
    v_and_b32 v115, 0xffff0000, v32
    v_mul_f32 v112, v112, v34
    v_mul_f32 v113, v113, v35
    v_mul_f32 v114, v114, v36
    v_mul_f32 v115, v115, v37
    v_cvt_pk_bf16_f32 v32, v112, v113
    v_lshlrev_b32 v112, 16, v32
    v_and_b32 v113, 0xffff0000, v32
    v_cvt_pk_bf16_f32 v32, v114, v115
    v_lshlrev_b32 v114, 16, v32
    v_and_b32 v115, 0xffff0000, v32
    v_lshlrev_b32 v32, 16, v46
    v_add_f32 v112, v112, v32
    v_and_b32 v32, 0xffff0000, v46
    v_add_f32 v113, v113, v32
    v_lshlrev_b32 v32, 16, v47
    v_add_f32 v114, v114, v32
    v_and_b32 v32, 0xffff0000, v47
    v_add_f32 v115, v115, v32
    v_cvt_pk_bf16_f32 v112, v112, v113
    v_cvt_pk_bf16_f32 v113, v114, v115
    ds_write_b64 v71, v[112:113] offset:0
    v_cvt_pk_bf16_f32 v32, v116, v117
    v_lshlrev_b32 v116, 16, v32
    v_and_b32 v117, 0xffff0000, v32
    v_cvt_pk_bf16_f32 v32, v118, v119
    v_lshlrev_b32 v118, 16, v32
    v_and_b32 v119, 0xffff0000, v32
    v_mul_f32 v116, v116, v38
    v_mul_f32 v117, v117, v39
    v_mul_f32 v118, v118, v40
    v_mul_f32 v119, v119, v41
    v_cvt_pk_bf16_f32 v32, v116, v117
    v_lshlrev_b32 v116, 16, v32
    v_and_b32 v117, 0xffff0000, v32
    v_cvt_pk_bf16_f32 v32, v118, v119
    v_lshlrev_b32 v118, 16, v32
    v_and_b32 v119, 0xffff0000, v32
    v_lshlrev_b32 v32, 16, v48
    v_add_f32 v116, v116, v32
    v_and_b32 v32, 0xffff0000, v48
    v_add_f32 v117, v117, v32
    v_lshlrev_b32 v32, 16, v49
    v_add_f32 v118, v118, v32
    v_and_b32 v32, 0xffff0000, v49
    v_add_f32 v119, v119, v32
    v_cvt_pk_bf16_f32 v116, v116, v117
    v_cvt_pk_bf16_f32 v117, v118, v119
    ds_write_b64 v71, v[116:117] offset:32
    v_cvt_pk_bf16_f32 v32, v120, v121
    v_lshlrev_b32 v120, 16, v32
    v_and_b32 v121, 0xffff0000, v32
    v_cvt_pk_bf16_f32 v32, v122, v123
    v_lshlrev_b32 v122, 16, v32
    v_and_b32 v123, 0xffff0000, v32
    v_mul_f32 v120, v120, v42
    v_mul_f32 v121, v121, v43
    v_mul_f32 v122, v122, v44
    v_mul_f32 v123, v123, v45
    v_cvt_pk_bf16_f32 v32, v120, v121
    v_lshlrev_b32 v120, 16, v32
    v_and_b32 v121, 0xffff0000, v32
    v_cvt_pk_bf16_f32 v32, v122, v123
    v_lshlrev_b32 v122, 16, v32
    v_and_b32 v123, 0xffff0000, v32
    v_lshlrev_b32 v32, 16, v50
    v_add_f32 v120, v120, v32
    v_and_b32 v32, 0xffff0000, v50
    v_add_f32 v121, v121, v32
    v_lshlrev_b32 v32, 16, v51
    v_add_f32 v122, v122, v32
    v_and_b32 v32, 0xffff0000, v51
    v_add_f32 v123, v123, v32
    v_cvt_pk_bf16_f32 v120, v120, v121
    v_cvt_pk_bf16_f32 v121, v122, v123
    ds_write_b64 v71, v[120:121] offset:64
    v_add_u32 v31, 24576, v31
    buffer_load_dwordx2 v[46:47], v31, s[44:47], 0 offen offset:0
    buffer_load_dwordx2 v[48:49], v31, s[44:47], 0 offen offset:32
    buffer_load_dwordx2 v[50:51], v31, s[44:47], 0 offen offset:64
    s_waitcnt vmcnt(0)
    v_cvt_pk_bf16_f32 v32, v124, v125
    v_lshlrev_b32 v124, 16, v32
    v_and_b32 v125, 0xffff0000, v32
    v_cvt_pk_bf16_f32 v32, v126, v127
    v_lshlrev_b32 v126, 16, v32
    v_and_b32 v127, 0xffff0000, v32
    v_mul_f32 v124, v124, v34
    v_mul_f32 v125, v125, v35
    v_mul_f32 v126, v126, v36
    v_mul_f32 v127, v127, v37
    v_cvt_pk_bf16_f32 v32, v124, v125
    v_lshlrev_b32 v124, 16, v32
    v_and_b32 v125, 0xffff0000, v32
    v_cvt_pk_bf16_f32 v32, v126, v127
    v_lshlrev_b32 v126, 16, v32
    v_and_b32 v127, 0xffff0000, v32
    v_lshlrev_b32 v32, 16, v46
    v_add_f32 v124, v124, v32
    v_and_b32 v32, 0xffff0000, v46
    v_add_f32 v125, v125, v32
    v_lshlrev_b32 v32, 16, v47
    v_add_f32 v126, v126, v32
    v_and_b32 v32, 0xffff0000, v47
    v_add_f32 v127, v127, v32
    v_cvt_pk_bf16_f32 v124, v124, v125
    v_cvt_pk_bf16_f32 v125, v126, v127
    ds_write_b64 v71, v[124:125] offset:1792
    v_cvt_pk_bf16_f32 v32, v128, v129
    v_lshlrev_b32 v128, 16, v32
    v_and_b32 v129, 0xffff0000, v32
    v_cvt_pk_bf16_f32 v32, v130, v131
    v_lshlrev_b32 v130, 16, v32
    v_and_b32 v131, 0xffff0000, v32
    v_mul_f32 v128, v128, v38
    v_mul_f32 v129, v129, v39
    v_mul_f32 v130, v130, v40
    v_mul_f32 v131, v131, v41
    v_cvt_pk_bf16_f32 v32, v128, v129
    v_lshlrev_b32 v128, 16, v32
    v_and_b32 v129, 0xffff0000, v32
    v_cvt_pk_bf16_f32 v32, v130, v131
    v_lshlrev_b32 v130, 16, v32
    v_and_b32 v131, 0xffff0000, v32
    v_lshlrev_b32 v32, 16, v48
    v_add_f32 v128, v128, v32
    v_and_b32 v32, 0xffff0000, v48
    v_add_f32 v129, v129, v32
    v_lshlrev_b32 v32, 16, v49
    v_add_f32 v130, v130, v32
    v_and_b32 v32, 0xffff0000, v49
    v_add_f32 v131, v131, v32
    v_cvt_pk_bf16_f32 v128, v128, v129
    v_cvt_pk_bf16_f32 v129, v130, v131
    ds_write_b64 v71, v[128:129] offset:1824
    v_cvt_pk_bf16_f32 v32, v132, v133
    v_lshlrev_b32 v132, 16, v32
    v_and_b32 v133, 0xffff0000, v32
    v_cvt_pk_bf16_f32 v32, v134, v135
    v_lshlrev_b32 v134, 16, v32
    v_and_b32 v135, 0xffff0000, v32
    v_mul_f32 v132, v132, v42
    v_mul_f32 v133, v133, v43
    v_mul_f32 v134, v134, v44
    v_mul_f32 v135, v135, v45
    v_cvt_pk_bf16_f32 v32, v132, v133
    v_lshlrev_b32 v132, 16, v32
    v_and_b32 v133, 0xffff0000, v32
    v_cvt_pk_bf16_f32 v32, v134, v135
    v_lshlrev_b32 v134, 16, v32
    v_and_b32 v135, 0xffff0000, v32
    v_lshlrev_b32 v32, 16, v50
    v_add_f32 v132, v132, v32
    v_and_b32 v32, 0xffff0000, v50
    v_add_f32 v133, v133, v32
    v_lshlrev_b32 v32, 16, v51
    v_add_f32 v134, v134, v32
    v_and_b32 v32, 0xffff0000, v51
    v_add_f32 v135, v135, v32
    v_cvt_pk_bf16_f32 v132, v132, v133
    v_cvt_pk_bf16_f32 v133, v134, v135
    ds_write_b64 v71, v[132:133] offset:1856
    s_waitcnt lgkmcnt(0)
    s_mov_b32 s36, 715827883
    s_mul_i32 s35, s33, 64
    s_lshr_b32 s37, s3, 1
    s_mul_i32 s37, s37, 32
    s_add_u32 s35, s35, s37
    s_mul_i32 s35, s35, 1536
    s_mul_i32 s37, s31, 192
    s_add_u32 s35, s35, s37
    s_and_b32 s37, s3, 1
    s_mul_i32 s37, s37, 96
    s_add_u32 s35, s35, s37
    s_mov_b32 s37, 1536
    v_add_u32 v27, 0, v2
    v_mul_hi_u32 v28, v27, s36
    v_mul_u32_u24 v29, 6, v28
    v_sub_u32 v29, v27, v29
    v_mul_u32_u24 v30, 112, v28
    v_lshl_add_u32 v30, v29, 4, v30
    v_add_u32 v30, s52, v30
    ds_read_b128 v[112:115], v30
    v_mul_lo_u32 v32, v28, s37
    v_lshl_add_u32 v34, v29, 4, v32
    s_waitcnt lgkmcnt(0)
    buffer_store_dwordx4 v[112:115], v34, s[20:23], s35 offen
    v_add_u32 v27, 64, v2
    v_mul_hi_u32 v28, v27, s36
    v_mul_u32_u24 v29, 6, v28
    v_sub_u32 v29, v27, v29
    v_mul_u32_u24 v30, 112, v28
    v_lshl_add_u32 v30, v29, 4, v30
    v_add_u32 v30, s52, v30
    ds_read_b128 v[116:119], v30
    v_mul_lo_u32 v32, v28, s37
    v_lshl_add_u32 v35, v29, 4, v32
    s_waitcnt lgkmcnt(0)
    buffer_store_dwordx4 v[116:119], v35, s[20:23], s35 offen
    v_add_u32 v27, 128, v2
    v_mul_hi_u32 v28, v27, s36
    v_mul_u32_u24 v29, 6, v28
    v_sub_u32 v29, v27, v29
    v_mul_u32_u24 v30, 112, v28
    v_lshl_add_u32 v30, v29, 4, v30
    v_add_u32 v30, s52, v30
    ds_read_b128 v[120:123], v30
    v_mul_lo_u32 v32, v28, s37
    v_lshl_add_u32 v36, v29, 4, v32
    s_waitcnt lgkmcnt(0)
    buffer_store_dwordx4 v[120:123], v36, s[20:23], s35 offen
    s_waitcnt vmcnt(0)
L_dit_fc2_kernel_1:
    s_endpgm
.section .rodata,"a"
.p2align 6
.amdhsa_kernel dit_fc2_kernel
  .amdhsa_next_free_vgpr 136
  .amdhsa_next_free_sgpr 100
  .amdhsa_accum_offset 136
  .amdhsa_group_segment_fixed_size 0
  .amdhsa_kernarg_size 80
  .amdhsa_user_sgpr_count 2
  .amdhsa_user_sgpr_kernarg_segment_ptr 1
  .amdhsa_system_sgpr_workgroup_id_x 1
.end_amdhsa_kernel
```
